```python
import torch

def _softmax(x, axis=-1):
    return torch.softmax(x, dim=axis)

def _gelu(x):
    return torch.nn.functional.gelu(x, approximate='tanh')

def _silu(x):
    return torch.nn.functional.silu(x)

def _sigmoid(x):
    return torch.sigmoid(x)

def _layernorm(x, axis=-1, eps=1e-05):
    m = x.mean(dim=axis, keepdim=True)
    v = x.var(dim=axis, keepdim=True, unbiased=False)
    return (x - m) / torch.sqrt(v + eps)

def _scatter_add(tgt, idx, src, axis=0):
    return tgt.clone().index_add_(axis, idx, src)

def _segment_sum(src, seg, n):
    out = torch.zeros((n,) + src.shape[1:], dtype=src.dtype)
    return out.index_add_(0, seg, src)

def _pad(x, pw):
    flat = tuple((v for pair in reversed(pw) for v in pair))
    return torch.nn.functional.pad(x, flat)
kernel_name = 'adaLN_cond__sliding_block_cached__geglu_ffn__decode'

def setup_inputs():

    _w = lambda a: (lambda t: t.to(torch.bfloat16) if t.is_floating_point() else t)(torch.as_tensor(a))

    def _A_setup():
        B, Sq, D = (4, 1, 512)
        Hq, Hkv, Sk, Dh = (32, 8, 16384, 128)
        assert Hq % Hkv == 0, (Hq, Hkv)
        return {'x': _w((lambda *s: torch.randn(*s, dtype=torch.bfloat16) * 0.05)(B, Sq, D)), 'k_cache': _w((lambda *s: torch.randn(*s, dtype=torch.bfloat16) * 1.6)(B, Hkv, Sk, Dh)), 'v_cache': _w((lambda *s: torch.randn(*s, dtype=torch.bfloat16) * 1.6)(B, Hkv, Sk, Dh)), 'wq': _w((lambda *s: torch.randn(*s, dtype=torch.bfloat16) * 1.6)(D, Hq * Dh) * D ** (-0.5)), 'wo': _w((lambda *s: torch.randn(*s, dtype=torch.bfloat16) * 1.6)(Hq * Dh, D) * (Hq * Dh) ** (-0.5))}
    _A_in = _A_setup()

    def _B_setup():
        B, S, D, F = (4, 1, 512, 1792)
        return {'x': _w((lambda *s: torch.randn(*s, dtype=torch.bfloat16) * 0.05)(B, S, D)), 'w_gate': _w((lambda *s: torch.randn(*s, dtype=torch.bfloat16) * 0.05)(D, F)), 'w_up': _w((lambda *s: torch.randn(*s, dtype=torch.bfloat16) * 0.05)(D, F)), 'w_down': _w((lambda *s: torch.randn(*s, dtype=torch.bfloat16) * 0.05)(F, D))}
    _B_in = _B_setup()
    return {'A_x': _A_in['x'], 'A_k_cache': _A_in['k_cache'], 'A_v_cache': _A_in['v_cache'], 'A_wq': _A_in['wq'], 'A_wo': _A_in['wo'], 'B_x': _B_in['x'], 'B_w_gate': _B_in['w_gate'], 'B_w_up': _B_in['w_up'], 'B_w_down': _B_in['w_down'], 'c': _w((lambda *s: torch.randn(*s, dtype=torch.bfloat16) * 0.2)(4, 512) * 8.0), 'w_mod': _w((lambda *s: torch.randn(*s, dtype=torch.bfloat16) * 0.2)(512, 6 * 512) * 512 ** (-0.5) * 8.0)}

def reference(A_x, A_k_cache, A_v_cache, A_wq, A_wo, B_x, B_w_gate, B_w_up, B_w_down, c, w_mod):

    def _A_ref(x, k_cache, v_cache, wq, wo):
        B, Sq, D = x.shape
        Hq, Dh = (32, 128)
        Hkv, Sk = (k_cache.shape[1], k_cache.shape[2])
        W = min(4096, max(256, Sk // 4))
        rep = Hq // Hkv
        q = (lambda x, *d: x.permute(*d))((x @ wq).reshape(B, Sq, Hq, Dh), 0, 2, 1, 3)
        k = (lambda x, n, axis: torch.repeat_interleave(x, n, dim=axis))(k_cache[:, :, Sk - W:, :], rep, axis=1)
        v = (lambda x, n, axis: torch.repeat_interleave(x, n, dim=axis))(v_cache[:, :, Sk - W:, :], rep, axis=1)
        scores = torch.einsum('bhqd,bhkd->bhqk', q, k) * Dh ** (-0.5)
        p = _softmax(scores, axis=-1)
        o = torch.einsum('bhqk,bhkd->bhqd', p, v)
        return (lambda x, *d: x.permute(*d))(o, 0, 2, 1, 3).reshape(B, Sq, Hq * Dh) @ wo

    def _B_ref(x, w_gate, w_up, w_down):
        return _gelu(x @ w_gate) * (x @ w_up) @ w_down
    x = A_x
    mod = (_silu(c) @ w_mod).reshape(c.shape[0], 6, 1, -1)
    sa, ca, ga, sb, cb, gb = (mod[:, 0].clone(), mod[:, 1].clone(), mod[:, 2].clone(), mod[:, 3].clone(), mod[:, 4].clone(), mod[:, 5].clone())
    h = _layernorm(x, axis=-1) * (1 + ca) + sa
    x = x + ga * _A_ref(h, A_k_cache, A_v_cache, A_wq, A_wo)
    h = _layernorm(x, axis=-1) * (1 + cb) + sb
    x = x + gb * _B_ref(h, B_w_gate, B_w_up, B_w_down)
    return x
```

```asm
; @launch grid=(256,1,1) block=(768,1,1) lds=43008
.amdgcn_target "amdgcn-amd-amdhsa--gfx950"
.text
.globl adaLN_cond__sliding_block_cached__geglu_ffn__decode_kernel
.p2align 12
.type adaLN_cond__sliding_block_cached__geglu_ffn__decode_kernel,@function
adaLN_cond__sliding_block_cached__geglu_ffn__decode_kernel:
    s_cmp_ge_u32 s2, 256
    s_cbranch_scc1 L_end
    s_load_dwordx16 s[4:19], s[0:1], 0
    s_load_dwordx8 s[20:27], s[0:1], 64
    s_load_dwordx2 s[30:31], s[0:1], 104
    v_lshrrev_b32 v1, 6, v0
    v_and_b32 v0, 63, v0
    s_and_b32 s33, s2, 7
    v_readfirstlane_b32 s32, v1
    s_lshr_b32 s34, s2, 3
    s_and_b32 s35, s34, 3
    s_cmp_lt_u32 s32, 4
    s_cbranch_scc0 L_str
    s_getpc_b64 s[58:59]
L_pc:
    s_lshl2_add_u32 s56, s34, s32
    s_min_u32 s56, s56, (L_last-L_pc)/256-1
    s_lshl_b32 s56, s56, 8
    v_lshl_add_u32 v3, v0, 2, s56
    global_load_dword v162, v3, s[58:59]
    s_cmp_eq_u32 s32, 1
    s_cselect_b32 s54, -1, 0
    s_mul_i32 s55, s32, 1280
    v_mov_b32 v1, s54
    v_lshl_add_u32 v2, v0, 2, s55
    ds_write_b32 v2, v1
    s_and_b32 s28, s34, 1
    s_sub_u32 s29, s34, 4
    s_cmp_lt_u32 s29, 16
    s_cbranch_scc0 L_MH
    s_lshr_b32 s54, s29, 1
    s_lshl3_add_u32 s3, s33, s54
    s_lshl_b32 s100, s3, 7
    s_lshl_b32 s101, s32, 19
    s_add_u32 s100, s100, s101
    s_lshl_b32 s101, s28, 21
    s_add_u32 s100, s100, s101
    v_lshrrev_b32 v1, 3, v0
    v_lshl_add_u32 v2, v1, 16, s100
    v_and_b32 v1, 7, v0
    v_lshl_add_u32 v2, v1, 4, v2
    s_mov_b32 s50, 4194304
    s_mov_b32 s51, 0x20000
    s_movk_i32 s55, 8192
    s_waitcnt lgkmcnt(0)
    s_mov_b64 s[48:49], s[10:11]
    buffer_load_dwordx4 v[32:35], v2, s[48:51], 0 offen nt
    buffer_load_dwordx4 v[36:39], v2, s[48:51], s55 offen nt
    s_lshl_b32 s54, s55, 1
    buffer_load_dwordx4 v[40:43], v2, s[48:51], s54 offen nt
    s_add_u32 s54, s54, s55
    buffer_load_dwordx4 v[44:47], v2, s[48:51], s54 offen nt
    s_add_u32 s54, s54, s55
    buffer_load_dwordx4 v[48:51], v2, s[48:51], s54 offen nt
    s_add_u32 s54, s54, s55
    buffer_load_dwordx4 v[52:55], v2, s[48:51], s54 offen nt
    s_add_u32 s54, s54, s55
    buffer_load_dwordx4 v[56:59], v2, s[48:51], s54 offen nt
    s_add_u32 s54, s54, s55
    buffer_load_dwordx4 v[60:63], v2, s[48:51], s54 offen nt
    s_load_dword s38, s[30:31], 0
    s_barrier
    s_branch L_Q
L_str:
    s_lshr_b32 s36, s34, 2
    s_sub_u32 s3, s32, 4
    s_lshl3_add_u32 s54, s35, s33
    s_lshl_b32 s54, s54, 7
    s_add_u32 s54, s54, s36
    s_lshl3_add_u32 s54, s54, s3
    s_addk_i32 s54, 768
    s_lshl_b32 s54, s54, 12
    v_bfe_u32 v1, v0, 2, 2
    v_lshrrev_b32 v2, 4, v0
    v_and_b32 v3, 3, v0
    v_lshlrev_b32 v6, 8, v1
    v_lshl_add_u32 v6, v2, 6, v6
    v_lshl_add_u32 v6, v3, 4, v6
    v_add_u32 v4, s54, v6
    v_lshl_add_u32 v5, v0, 4, s54
    s_lshr_b32 s98, s36, 1
    s_lshl_b32 s98, s98, 18
    s_mov_b32 s46, 134217728
    s_mov_b32 s47, 0x20000
    s_sub_u32 s54, s34, 20
    s_bitcmp1_b32 s33, 0
    s_cselect_b32 s55, 6, 8
    s_cmp_lt_u32 s34, 28
    s_waitcnt lgkmcnt(0)
    s_mov_b64 s[44:45], s[6:7]
    s_cbranch_scc0 L_sH0
    s_barrier
L_sH0:
    buffer_load_dwordx4 v[32:35], v4, s[44:47], s98 offen offset:0 nt
    buffer_load_dwordx4 v[36:39], v4, s[44:47], s98 offen offset:1024 nt
    buffer_load_dwordx4 v[40:43], v4, s[44:47], s98 offen offset:2048 nt
    s_cbranch_scc0 L_sH
    s_cmp_lt_u32 s54, s55
    s_cbranch_scc1 L_sF
    s_branch L_sN0
L_MH:
    s_cmp_lt_u32 s34, 28
    s_cbranch_scc0 L_H
    s_sub_u32 s54, s34, 16
    s_cmp_lt_u32 s34, 4
    s_cselect_b32 s54, s34, s54
    s_lshr_b32 s54, s54, 1
    s_lshl3_add_u32 s3, s54, s33
    s_mov_b32 s54, s3
    s_cmp_eq_u32 s54, 19
    s_cselect_b32 s3, 41, s3
    s_cmp_eq_u32 s54, 41
    s_cselect_b32 s3, 19, s3
    s_cmp_eq_u32 s54, 27
    s_cselect_b32 s3, 45, s3
    s_cmp_eq_u32 s54, 45
    s_cselect_b32 s3, 27, s3
    s_cmp_eq_u32 s54, 35
    s_cselect_b32 s3, 47, s3
    s_cmp_eq_u32 s54, 47
    s_cselect_b32 s3, 35, s3
    s_lshl_b32 s100, s3, 7
    s_mul_i32 s101, s32, 393216
    s_add_u32 s100, s100, s101
    s_mul_i32 s101, s28, 1572864
    s_add_u32 s100, s100, s101
    v_lshrrev_b32 v1, 3, v0
    v_mul_u32_u24 v1, 49152, v1
    v_add_u32 v2, s100, v1
    v_and_b32 v1, 7, v0
    v_lshl_add_u32 v2, v1, 4, v2
    s_lshl_b32 s100, s32, 10
    s_lshl_b32 s101, s28, 9
    s_add_u32 s100, s100, s101
    v_lshl_add_u32 v1, v0, 3, s100
    s_mov_b32 s50, 3145728
    s_mov_b32 s51, 0x20000
    s_mov_b32 s46, 4096
    s_mov_b32 s47, 0x20000
    s_movk_i32 s55, 6144
    s_waitcnt lgkmcnt(0)
    s_mov_b64 s[44:45], s[22:23]
    s_mov_b64 s[48:49], s[24:25]
    buffer_load_dwordx2 v[8:9], v1, s[44:47], 0 offen
    buffer_load_dwordx4 v[32:35], v2, s[48:51], 0 offen nt
    buffer_load_dwordx4 v[36:39], v2, s[48:51], s55 offen nt
    s_lshl_b32 s54, s55, 1
    buffer_load_dwordx4 v[40:43], v2, s[48:51], s54 offen nt
    s_add_u32 s54, s54, s55
    buffer_load_dwordx4 v[44:47], v2, s[48:51], s54 offen nt
    s_add_u32 s54, s54, s55
    buffer_load_dwordx4 v[48:51], v2, s[48:51], s54 offen nt
    s_add_u32 s54, s54, s55
    buffer_load_dwordx4 v[52:55], v2, s[48:51], s54 offen nt
    s_add_u32 s54, s54, s55
    buffer_load_dwordx4 v[56:59], v2, s[48:51], s54 offen nt
    s_add_u32 s54, s54, s55
    buffer_load_dwordx4 v[60:63], v2, s[48:51], s54 offen nt
    s_load_dword s38, s[30:31], 0
    s_barrier
L_M2:
    s_mov_b32 s42, 16777216
    s_mov_b32 s43, 0x20000
    s_mov_b64 s[40:41], s[30:31]
    s_mov_b32 s52, 0x05040100
    s_mov_b32 s53, 0x07060302
    s_mov_b32 s72, 0xffff0000
    v_mov_b32 v167, 0
    s_getreg_b32 s73, hwreg(HW_REG_XCC_ID, 0, 4)
    v_mov_b32 v166, 0
    s_mov_b32 s98, 0
    s_mov_b32 s100, 2048
    s_mul_i32 s101, s32, 1088
    s_add_u32 s100, s100, s101
    v_lshl_add_u32 v5, v0, 3, s100
    s_mov_b32 s100, 1572864
    s_lshl_b32 s101, s3, 9
    s_add_u32 s100, s100, s101
    s_lshl_b32 s101, s32, 7
    s_add_u32 s100, s100, s101
    s_mul_i32 s101, s28, 98304
    s_add_u32 s100, s100, s101
    v_lshrrev_b32 v1, 4, v0
    v_mul_u32_u24 v1, 24576, v1
    v_add_u32 v7, s100, v1
    v_and_b32 v1, 15, v0
    v_lshl_add_u32 v7, v1, 3, v7
    s_mov_b32 s100, 2048
    s_lshl_b32 s101, s32, 7
    s_add_u32 s100, s100, s101
    v_and_b32 v1, 3, v0
    v_mul_u32_u24 v1, 1088, v1
    v_add_u32 v4, s100, v1
    v_bfe_u32 v1, v0, 2, 1
    v_lshl_add_u32 v4, v1, 4, v4
    v_lshrrev_b32 v1, 4, v0
    v_lshl_add_u32 v4, v1, 5, v4
    s_mov_b32 s100, 6656
    s_mul_i32 s101, s32, 2080
    s_add_u32 s100, s100, s101
    v_bfe_u32 v1, v0, 3, 1
    v_mul_u32_u24 v1, 1040, v1
    v_add_u32 v165, s100, v1
    v_and_b32 v1, 7, v0
    v_lshl_add_u32 v165, v1, 4, v165
    s_mov_b32 s100, 6656
    s_lshl_b32 s101, s32, 5
    s_add_u32 s100, s100, s101
    v_lshrrev_b32 v1, 4, v0
    v_mul_u32_u24 v1, 2080, v1
    v_add_u32 v6, s100, v1
    v_and_b32 v1, 7, v0
    v_lshl_add_u32 v6, v1, 7, v6
    v_bfe_u32 v1, v0, 3, 1
    v_lshl_add_u32 v6, v1, 4, v6
    s_mov_b32 s70, 0xff0000ff
    s_mov_b32 s71, 0
    s_waitcnt lgkmcnt(0)
    s_lshl_b32 s37, s38, 1
    s_add_u32 s37, s37, 0x9E3779B8
    s_mov_b32 s100, 57344
    s_lshl_b32 s101, s33, 8
    s_add_u32 s100, s100, s101
    s_lshl3_add_u32 s100, s34, s100
    v_mov_b32 v1, s100
    v_mov_b32 v2, s73
    v_mov_b32 v3, s37
    s_mov_b64 exec, 1
    buffer_store_dwordx2 v[2:3], v1, s[40:43], 0 offen
    s_mov_b64 exec, -1
Lxt_1:
    s_waitcnt vmcnt(9)
    v_lshlrev_b32 v16, 16, v8
    v_and_b32 v17, s72, v8
    v_lshlrev_b32 v18, 16, v9
    v_and_b32 v19, s72, v9
    s_mov_b32 s54, 3216550459
    v_mul_f32 v24, s54, v16
    v_mul_f32 v25, s54, v17
    v_mul_f32 v26, s54, v18
    v_mul_f32 v27, s54, v19
    v_exp_f32 v24, v24
    v_exp_f32 v25, v25
    v_exp_f32 v26, v26
    v_exp_f32 v27, v27
    v_add_f32 v24, 1.0, v24
    v_add_f32 v25, 1.0, v25
    v_add_f32 v26, 1.0, v26
    v_add_f32 v27, 1.0, v27
    v_rcp_f32 v24, v24
    v_rcp_f32 v25, v25
    v_rcp_f32 v26, v26
    v_rcp_f32 v27, v27
    v_mul_f32 v16, v16, v24
    v_mul_f32 v17, v17, v25
    v_mul_f32 v18, v18, v26
    v_mul_f32 v19, v19, v27
    v_cvt_pk_bf16_f32 v28, v16, v17
    v_cvt_pk_bf16_f32 v29, v18, v19
    ds_write_b64 v5, v[28:29]
    v_mov_b32 v1, 1
    s_mov_b64 exec, 1
    ds_add_u32 v167, v1 offset:0
    s_mov_b64 exec, -1
    s_waitcnt vmcnt(7)
    v_perm_b32 v96, v36, v32, s52
    v_perm_b32 v100, v36, v32, s53
    v_perm_b32 v104, v37, v33, s52
    v_perm_b32 v108, v37, v33, s53
    v_perm_b32 v112, v38, v34, s52
    v_perm_b32 v116, v38, v34, s53
    v_perm_b32 v120, v39, v35, s52
    v_perm_b32 v124, v39, v35, s53
    s_waitcnt vmcnt(5)
    v_perm_b32 v97, v44, v40, s52
    v_perm_b32 v101, v44, v40, s53
    v_perm_b32 v105, v45, v41, s52
    v_perm_b32 v109, v45, v41, s53
    v_perm_b32 v113, v46, v42, s52
    v_perm_b32 v117, v46, v42, s53
    v_perm_b32 v121, v47, v43, s52
    v_perm_b32 v125, v47, v43, s53
    s_waitcnt vmcnt(3)
    v_perm_b32 v98, v52, v48, s52
    v_perm_b32 v102, v52, v48, s53
    v_perm_b32 v106, v53, v49, s52
    v_perm_b32 v110, v53, v49, s53
    v_perm_b32 v114, v54, v50, s52
    v_perm_b32 v118, v54, v50, s53
    v_perm_b32 v122, v55, v51, s52
    v_perm_b32 v126, v55, v51, s53
    s_waitcnt vmcnt(1)
    v_perm_b32 v99, v60, v56, s52
    v_perm_b32 v103, v60, v56, s53
    v_perm_b32 v107, v61, v57, s52
    v_perm_b32 v111, v61, v57, s53
    v_perm_b32 v115, v62, v58, s52
    v_perm_b32 v119, v62, v58, s53
    v_perm_b32 v123, v63, v59, s52
    v_perm_b32 v127, v63, v59, s53
    s_mov_b32 s73, 0
    s_mov_b32 s39, 320000
Lw_2:
    ds_read_b32 v1, v167 offset:0
    s_sub_u32 s39, s39, 1
    s_cbranch_scc1 Lwx_3
    s_waitcnt lgkmcnt(0)
    v_readfirstlane_b32 s54, v1
    s_nop 0
    s_cmp_lt_u32 s54, 4
    s_cbranch_scc1 Lw_2
Lwx_3:
    s_waitcnt lgkmcnt(0)
    ds_read_b128 v[8:11], v4
    s_waitcnt lgkmcnt(0)
    v_mfma_f32_16x16x32_bf16 v[128:131], v[8:11], v[96:99], 0
    v_mfma_f32_16x16x32_bf16 v[132:135], v[8:11], v[100:103], 0
    v_mfma_f32_16x16x32_bf16 v[136:139], v[8:11], v[104:107], 0
    v_mfma_f32_16x16x32_bf16 v[140:143], v[8:11], v[108:111], 0
    v_mfma_f32_16x16x32_bf16 v[144:147], v[8:11], v[112:115], 0
    v_mfma_f32_16x16x32_bf16 v[148:151], v[8:11], v[116:119], 0
    v_mfma_f32_16x16x32_bf16 v[152:155], v[8:11], v[120:123], 0
    v_mfma_f32_16x16x32_bf16 v[156:159], v[8:11], v[124:127], 0
    s_mov_b64 exec, s[70:71]
    ds_write_b128 v165, v[128:131] offset:0
    ds_write_b128 v165, v[132:135] offset:128
    ds_write_b128 v165, v[136:139] offset:256
    ds_write_b128 v165, v[140:143] offset:384
    ds_write_b128 v165, v[144:147] offset:512
    ds_write_b128 v165, v[148:151] offset:640
    ds_write_b128 v165, v[152:155] offset:768
    ds_write_b128 v165, v[156:159] offset:896
    s_mov_b64 exec, -1
    v_mov_b32 v1, 1
    s_mov_b64 exec, 1
    ds_add_u32 v167, v1 offset:4
    s_mov_b64 exec, -1
    s_cmp_lg_u32 s73, 0
    s_cselect_b32 s66, 0x55555555, 0
    s_cselect_b32 s67, 0x55555555, 0
    s_cselect_b32 s68, 0, 0x55555555
    s_cselect_b32 s69, 0, 0x55555555
    s_add_u32 s55, s37, s73
    v_mov_b32 v17, s55
    v_mov_b32 v19, s55
    s_mov_b32 s39, 320000
Lw_4:
    ds_read_b32 v1, v167 offset:4
    s_sub_u32 s39, s39, 1
    s_cbranch_scc1 Lwx_5
    s_waitcnt lgkmcnt(0)
    v_readfirstlane_b32 s54, v1
    s_nop 0
    s_cmp_lt_u32 s54, 4
    s_cbranch_scc1 Lw_4
Lwx_5:
    s_waitcnt lgkmcnt(0)
    ds_read_b128 v[8:11], v6
    ds_read_b128 v[12:15], v6 offset:1040
    s_waitcnt lgkmcnt(0)
    v_pk_add_f32 v[8:9], v[8:9], v[12:13]
    v_pk_add_f32 v[10:11], v[10:11], v[14:15]
    s_nop 1
    v_permlane32_swap_b32 v8, v10
    v_permlane32_swap_b32 v9, v11
    v_add_f32 v8, v8, v10
    v_add_f32 v9, v9, v11
    s_nop 1
    v_permlane16_swap_b32 v8, v9
    v_add_f32 v8, v8, v9
    v_mov_b32 v16, v8
    s_nop 0
    v_mov_b32_dpp v18, v8 quad_perm:[1,1,3,3] row_mask:0xf bank_mask:0xf
    s_mov_b64 exec, s[66:67]
    buffer_store_dwordx4 v[16:19], v7, s[40:43], 0 offen
    s_mov_b64 exec, s[68:69]
    buffer_store_dwordx4 v[16:19], v7, s[40:43], 0 offen sc1
    s_mov_b64 exec, -1
    s_branch L_pubd
L_H:
    s_lshl_b32 s100, s35, 10
    s_lshl_b32 s101, s32, 8
    s_add_u32 s100, s100, s101
    v_lshl_add_u32 v1, v0, 2, s100
    v_xor_b32 v2, 256, v1
    v_xor_b32 v3, 512, v1
    v_xor_b32 v4, 768, v1
    s_waitcnt lgkmcnt(0)
    s_mov_b32 s46, 4096
    s_mov_b32 s47, 0x20000
    s_mov_b64 s[44:45], s[4:5]
    buffer_load_dword v8, v1, s[44:47], 0 offen
    buffer_load_dword v9, v2, s[44:47], 0 offen
    buffer_load_dword v10, v3, s[44:47], 0 offen
    buffer_load_dword v11, v4, s[44:47], 0 offen
    s_load_dword s38, s[30:31], 0
    s_mov_b32 s42, 16777216
    s_mov_b32 s43, 0x20000
    s_mov_b64 s[40:41], s[30:31]
    s_mov_b32 s52, 0x05040100
    s_mov_b32 s53, 0x07060302
    s_mov_b32 s72, 0xffff0000
    v_mov_b32 v167, 0
    s_getreg_b32 s73, hwreg(HW_REG_XCC_ID, 0, 4)
    v_mov_b32 v166, 0
    s_mov_b32 s98, 0
    s_barrier
    s_mov_b32 s100, 1572864
    s_mul_i32 s101, s35, 24576
    s_add_u32 s100, s100, s101
    s_lshl_b32 s101, s32, 10
    s_add_u32 s100, s100, s101
    v_lshl_add_u32 v164, v0, 4, s100
    s_mov_b32 s100, 57344
    s_lshl_b32 s101, s33, 8
    s_add_u32 s100, s100, s101
    v_and_b32 v1, 31, v0
    v_lshl_add_u32 v163, v1, 3, s100
    s_mov_b32 s100, 1507328
    s_lshl_b32 s101, s33, 13
    s_add_u32 s100, s100, s101
    s_lshl_b32 s101, s35, 11
    s_add_u32 s100, s100, s101
    s_lshl_b32 s101, s32, 9
    s_add_u32 s100, s100, s101
    v_lshl_add_u32 v7, v0, 3, s100
    s_waitcnt lgkmcnt(0)
    s_lshl_b32 s37, s38, 1
    s_add_u32 s37, s37, 0x9E3779B8
    s_mov_b32 exec_lo, 0x00010001
    s_mov_b32 exec_hi, 0x00010001
    buffer_load_dword v16, v7, s[40:43], 0 offen sc1
    s_mov_b64 exec, -1
    s_cmp_lg_u32 s32, 1
    s_cbranch_scc1 Lxt_6
    s_mov_b32 s100, 57344
    s_lshl_b32 s101, s33, 8
    s_add_u32 s100, s100, s101
    s_lshl3_add_u32 s100, s34, s100
    v_mov_b32 v1, s100
    v_mov_b32 v2, s73
    v_mov_b32 v3, s37
    s_mov_b64 exec, 1
    buffer_store_dwordx2 v[2:3], v1, s[40:43], 0 offen
    s_mov_b64 exec, -1
Lxt_6:
    s_waitcnt vmcnt(0)
    v_lshlrev_b32 v128, 16, v8
    v_and_b32 v129, s72, v8
    v_lshlrev_b32 v130, 16, v9
    v_and_b32 v131, s72, v9
    v_lshlrev_b32 v132, 16, v10
    v_and_b32 v133, s72, v10
    v_lshlrev_b32 v134, 16, v11
    v_and_b32 v135, s72, v11
    v_readfirstlane_b32 s100, v128
    s_nop 1
    v_pk_add_f32 v[136:137], v[128:129], s[100:101] op_sel_hi:[1,0] neg_lo:[0,1] neg_hi:[0,1]
    v_pk_add_f32 v[138:139], v[130:131], s[100:101] op_sel_hi:[1,0] neg_lo:[0,1] neg_hi:[0,1]
    v_pk_add_f32 v[140:141], v[132:133], s[100:101] op_sel_hi:[1,0] neg_lo:[0,1] neg_hi:[0,1]
    v_pk_add_f32 v[142:143], v[134:135], s[100:101] op_sel_hi:[1,0] neg_lo:[0,1] neg_hi:[0,1]
    v_pk_add_f32 v[144:145], v[136:137], v[138:139]
    v_pk_mul_f32 v[146:147], v[136:137], v[136:137]
    v_pk_fma_f32 v[146:147], v[138:139], v[138:139], v[146:147]
    v_pk_add_f32 v[136:137], v[140:141], v[142:143]
    v_pk_fma_f32 v[146:147], v[140:141], v[140:141], v[146:147]
    v_pk_add_f32 v[144:145], v[144:145], v[136:137]
    v_pk_fma_f32 v[146:147], v[142:143], v[142:143], v[146:147]
    v_add_f32 v144, v144, v145
    v_add_f32 v146, v146, v147
    s_nop 1
    v_permlane32_swap_b32 v144, v146
    v_add_f32 v144, v144, v146
    s_nop 1
    v_add_f32_dpp v144, v144, v144 quad_perm:[1,0,3,2] row_mask:0xf bank_mask:0xf
    s_nop 1
    v_add_f32_dpp v144, v144, v144 quad_perm:[2,3,0,1] row_mask:0xf bank_mask:0xf
    s_nop 1
    v_add_f32_dpp v144, v144, v144 row_half_mirror row_mask:0xf bank_mask:0xf
    s_nop 1
    v_add_f32_dpp v144, v144, v144 row_mirror row_mask:0xf bank_mask:0xf
    s_nop 0
    v_readlane_b32 s54, v144, 0
    v_readlane_b32 s55, v144, 16
    v_readlane_b32 s56, v144, 32
    v_readlane_b32 s57, v144, 48
    v_mov_b32 v146, 0x3b000000
    v_mul_f32 v144, s54, v146
    v_mul_f32 v145, s56, v146
    v_fmac_f32 v144, s55, v146
    v_fmac_f32 v145, s57, v146
    v_fma_f32 v145, -v144, v144, v145
    v_add_f32 v144, s100, v144
    v_max_f32 v145, 0, v145
    v_cvt_pk_bf16_f32 v146, v144, v145
    v_lshlrev_b32 v144, 16, v146
    v_and_b32 v146, s72, v146
    v_add_f32 v146, 0x3727c5ac, v146
    v_cvt_pk_bf16_f32 v146, v146, v146
    v_and_b32 v146, s72, v146
    v_sqrt_f32 v146, v146
    v_pk_add_f32 v[128:129], v[128:129], v[144:145] op_sel_hi:[1,0] neg_lo:[0,1] neg_hi:[0,1]
    v_pk_add_f32 v[130:131], v[130:131], v[144:145] op_sel_hi:[1,0] neg_lo:[0,1] neg_hi:[0,1]
    v_pk_add_f32 v[132:133], v[132:133], v[144:145] op_sel_hi:[1,0] neg_lo:[0,1] neg_hi:[0,1]
    v_pk_add_f32 v[134:135], v[134:135], v[144:145] op_sel_hi:[1,0] neg_lo:[0,1] neg_hi:[0,1]
    v_cvt_pk_bf16_f32 v146, v146, v146
    v_and_b32 v146, s72, v146
    v_rcp_f32 v146, v146
    v_cvt_pk_bf16_f32 v136, v128, v129
    v_cvt_pk_bf16_f32 v137, v130, v131
    v_cvt_pk_bf16_f32 v138, v132, v133
    v_cvt_pk_bf16_f32 v139, v134, v135
    v_lshlrev_b32 v128, 16, v136
    v_and_b32 v129, s72, v136
    v_lshlrev_b32 v130, 16, v137
    v_and_b32 v131, s72, v137
    v_lshlrev_b32 v132, 16, v138
    v_and_b32 v133, s72, v138
    v_lshlrev_b32 v134, 16, v139
    v_and_b32 v135, s72, v139
    v_pk_mul_f32 v[128:129], v[128:129], v[146:147] op_sel_hi:[1,0]
    v_pk_mul_f32 v[130:131], v[130:131], v[146:147] op_sel_hi:[1,0]
    v_pk_mul_f32 v[132:133], v[132:133], v[146:147] op_sel_hi:[1,0]
    v_pk_mul_f32 v[134:135], v[134:135], v[146:147] op_sel_hi:[1,0]
    v_cvt_pk_bf16_f32 v136, v128, v129
    v_cvt_pk_bf16_f32 v137, v130, v131
    v_cvt_pk_bf16_f32 v138, v132, v133
    v_cvt_pk_bf16_f32 v139, v134, v135
    v_lshlrev_b32 v128, 16, v136
    v_and_b32 v129, s72, v136
    v_lshlrev_b32 v130, 16, v137
    v_and_b32 v131, s72, v137
    v_lshlrev_b32 v132, 16, v138
    v_and_b32 v133, s72, v138
    v_lshlrev_b32 v134, 16, v139
    v_and_b32 v135, s72, v139
    s_mov_b32 s55, 4096
    s_mov_b32 s56, 98304
    s_mov_b32 s57, 102400
    s_sleep 16
    s_mov_b32 s39, 40000
    buffer_load_dwordx4 v[32:35], v164, s[40:43], 0 offen sc1
    buffer_load_dwordx4 v[36:39], v164, s[40:43], s56 offen sc1
    buffer_load_dwordx4 v[40:43], v164, s[40:43], s55 offen sc1
    buffer_load_dwordx4 v[44:47], v164, s[40:43], s57 offen sc1
    buffer_load_dwordx2 v[48:49], v163, s[40:43], 0 offen sc1
Lpp_7:
    s_waitcnt vmcnt(0)
    v_max3_u32 v24, v33, v35, v37
    v_min3_u32 v25, v33, v35, v37
    v_max3_u32 v24, v24, v39, v41
    v_min3_u32 v25, v25, v39, v41
    v_max3_u32 v24, v24, v43, v45
    v_min3_u32 v25, v25, v43, v45
    v_max3_u32 v24, v24, v47, v47
    v_min3_u32 v25, v25, v47, v47
    v_xor_b32 v24, s37, v24
    v_xor_b32 v25, s37, v25
    v_or_b32 v24, v24, v25
    v_cmp_lt_u32 vcc, 0, v24
    s_cbranch_vccz Lppd_9
    buffer_load_dwordx4 v[32:35], v164, s[40:43], 0 offen sc1
    buffer_load_dwordx4 v[36:39], v164, s[40:43], s56 offen sc1
    buffer_load_dwordx4 v[40:43], v164, s[40:43], s55 offen sc1
    buffer_load_dwordx4 v[44:47], v164, s[40:43], s57 offen sc1
    buffer_load_dwordx2 v[48:49], v163, s[40:43], 0 offen sc1
    s_sub_u32 s39, s39, 1
    s_cbranch_scc0 Lpp_7
    s_waitcnt vmcnt(0)
Lppd_9:
    v_add_f32 v136, v40, v44
    v_add_f32 v138, v32, v36
    v_add_f32 v137, v42, v46
    v_add_f32 v139, v34, v38
    v_cmp_ne_u32 vcc, s73, v48
    v_cmp_ne_u32 s[56:57], s37, v49
Lppx_8:
    v_cvt_pk_bf16_f32 v24, v136, v137
    v_cvt_pk_bf16_f32 v25, v138, v139
    v_lshlrev_b32 v136, 16, v24
    v_and_b32 v137, s72, v24
    v_lshlrev_b32 v138, 16, v25
    v_and_b32 v139, s72, v25
    s_or_b64 vcc, vcc, s[56:57]
    s_cselect_b32 s73, 0, 1
    v_add_f32 v136, 1.0, v136
    v_add_f32 v137, 1.0, v137
    s_add_u32 s55, s37, s73
    v_cvt_pk_bf16_f32 v24, v136, v137
    v_lshlrev_b32 v136, 16, v24
    v_and_b32 v137, s72, v24
    s_cmp_lg_u32 s73, 0
    s_cselect_b32 s66, 0x55555555, 0
    s_cselect_b32 s67, 0x55555555, 0
    s_cselect_b32 s68, 0, 0x55555555
    s_cselect_b32 s69, 0, 0x55555555
    v_pk_mul_f32 v[128:129], v[128:129], v[136:137]
    v_cvt_pk_bf16_f32 v24, v128, v129
    v_lshlrev_b32 v128, 16, v24
    v_and_b32 v129, s72, v24
    v_pk_add_f32 v[128:129], v[128:129], v[138:139]
    v_cvt_pk_bf16_f32 v16, v128, v129
    v_mov_b32 v17, s55
    v_mov_b32 v19, s55
    v_mov_b32_dpp v18, v16 quad_perm:[1,1,3,3] row_mask:0xf bank_mask:0xf
    s_mov_b64 exec, s[66:67]
    buffer_store_dwordx4 v[16:19], v7, s[40:43], 0 offen
    s_mov_b64 exec, s[68:69]
    buffer_store_dwordx4 v[16:19], v7, s[40:43], 0 offen sc1
    s_mov_b64 exec, -1
    s_branch L_pubd
L_Q:
    s_mov_b32 s42, 16777216
    s_mov_b32 s43, 0x20000
    s_mov_b64 s[40:41], s[30:31]
    s_mov_b32 s52, 0x05040100
    s_mov_b32 s53, 0x07060302
    s_mov_b32 s72, 0xffff0000
    v_mov_b32 v167, 0
    s_getreg_b32 s73, hwreg(HW_REG_XCC_ID, 0, 4)
    s_lshl_b32 s98, s29, 2
    s_add_u32 s98, s98, s32
    s_lshr_b32 s54, s98, 4
    s_and_b32 s55, s33, 1
    s_and_b32 s56, s98, 15
    s_mov_b32 s100, 983040
    s_lshl_b32 s101, s54, 11
    s_add_u32 s100, s100, s101
    s_lshl_b32 s101, s55, 10
    s_add_u32 s100, s100, s101
    s_lshl_b32 s101, s56, 6
    s_add_u32 s100, s100, s101
    v_lshrrev_b32 v1, 2, v0
    v_lshl_add_u32 v166, v1, 13, s100
    v_and_b32 v1, 3, v0
    v_lshl_add_u32 v166, v1, 4, v166
    s_mov_b32 s100, 1835008
    s_lshl_b32 s101, s3, 9
    s_add_u32 s100, s100, s101
    s_lshl_b32 s101, s32, 7
    s_add_u32 s100, s100, s101
    s_lshl_b32 s101, s28, 15
    s_add_u32 s100, s100, s101
    v_lshrrev_b32 v1, 4, v0
    v_lshl_add_u32 v7, v1, 16, s100
    v_and_b32 v1, 15, v0
    v_lshl_add_u32 v7, v1, 3, v7
    s_mov_b32 s100, 2048
    s_mul_i32 s101, s32, 1088
    s_add_u32 s100, s100, s101
    v_lshl_add_u32 v5, v0, 3, s100
    s_mov_b32 s100, 1507328
    s_lshl_b32 s101, s33, 13
    s_add_u32 s100, s100, s101
    s_lshl_b32 s101, s32, 11
    s_add_u32 s100, s100, s101
    s_lshl_b32 s101, s28, 10
    s_add_u32 s100, s100, s101
    v_lshl_add_u32 v164, v0, 4, s100
    s_mov_b32 s100, 2048
    s_lshl_b32 s101, s32, 7
    s_add_u32 s100, s100, s101
    v_and_b32 v1, 3, v0
    v_mul_u32_u24 v1, 1088, v1
    v_add_u32 v4, s100, v1
    v_bfe_u32 v1, v0, 2, 1
    v_lshl_add_u32 v4, v1, 4, v4
    v_lshrrev_b32 v1, 4, v0
    v_lshl_add_u32 v4, v1, 5, v4
    s_mov_b32 s100, 6656
    s_mul_i32 s101, s32, 2080
    s_add_u32 s100, s100, s101
    v_bfe_u32 v1, v0, 3, 1
    v_mul_u32_u24 v1, 1040, v1
    v_add_u32 v165, s100, v1
    v_and_b32 v1, 7, v0
    v_lshl_add_u32 v165, v1, 4, v165
    s_mov_b32 s100, 6656
    s_lshl_b32 s101, s32, 5
    s_add_u32 s100, s100, s101
    v_lshrrev_b32 v1, 4, v0
    v_mul_u32_u24 v1, 2080, v1
    v_add_u32 v6, s100, v1
    v_and_b32 v1, 7, v0
    v_lshl_add_u32 v6, v1, 7, v6
    v_bfe_u32 v1, v0, 3, 1
    v_lshl_add_u32 v6, v1, 4, v6
    s_mov_b32 s70, 0xff0000ff
    s_mov_b32 s71, 0
    s_waitcnt lgkmcnt(0)
    s_lshl_b32 s37, s38, 1
    s_add_u32 s37, s37, 0x9E3779B8
    s_mov_b32 exec_lo, 0x00010001
    s_mov_b32 exec_hi, 0x00010001
    buffer_load_dword v16, v7, s[40:43], 0 offen sc1
    s_mov_b64 exec, -1
    s_cmp_lg_u32 s32, 1
    s_cbranch_scc1 Lxt_10
    s_mov_b32 s100, 57344
    s_lshl_b32 s101, s33, 8
    s_add_u32 s100, s100, s101
    s_lshl3_add_u32 s100, s34, s100
    v_mov_b32 v1, s100
    v_mov_b32 v2, s73
    v_mov_b32 v3, s37
    s_mov_b64 exec, 1
    buffer_store_dwordx2 v[2:3], v1, s[40:43], 0 offen
    s_mov_b64 exec, -1
Lxt_10:
    s_waitcnt vmcnt(0)
    s_nop 0
    v_perm_b32 v96, v36, v32, s52
    v_perm_b32 v100, v36, v32, s53
    v_perm_b32 v104, v37, v33, s52
    v_perm_b32 v108, v37, v33, s53
    v_perm_b32 v112, v38, v34, s52
    v_perm_b32 v116, v38, v34, s53
    v_perm_b32 v120, v39, v35, s52
    v_perm_b32 v124, v39, v35, s53
    v_perm_b32 v97, v44, v40, s52
    v_perm_b32 v101, v44, v40, s53
    v_perm_b32 v105, v45, v41, s52
    v_perm_b32 v109, v45, v41, s53
    v_perm_b32 v113, v46, v42, s52
    v_perm_b32 v117, v46, v42, s53
    v_perm_b32 v121, v47, v43, s52
    v_perm_b32 v125, v47, v43, s53
    v_perm_b32 v98, v52, v48, s52
    v_perm_b32 v102, v52, v48, s53
    v_perm_b32 v106, v53, v49, s52
    v_perm_b32 v110, v53, v49, s53
    v_perm_b32 v114, v54, v50, s52
    v_perm_b32 v118, v54, v50, s53
    v_perm_b32 v122, v55, v51, s52
    v_perm_b32 v126, v55, v51, s53
    v_perm_b32 v99, v60, v56, s52
    v_perm_b32 v103, v60, v56, s53
    v_perm_b32 v107, v61, v57, s52
    v_perm_b32 v111, v61, v57, s53
    v_perm_b32 v115, v62, v58, s52
    v_perm_b32 v119, v62, v58, s53
    v_perm_b32 v123, v63, v59, s52
    v_perm_b32 v127, v63, v59, s53
    s_mov_b32 s39, 40000
    buffer_load_dwordx4 v[32:35], v164, s[40:43], 0 offen sc1
    s_sleep 12
    buffer_load_dwordx4 v[36:39], v164, s[40:43], 0 offen sc1
    s_sleep 12
    buffer_load_dwordx4 v[40:43], v164, s[40:43], 0 offen sc1
Lpp_11:
    s_waitcnt vmcnt(2)
    s_nop 0
    v_xor_b32 v24, s37, v33
    v_xor_b32 v25, s37, v35
    v_or_b32 v24, v24, v25
    v_cmp_lt_u32 vcc, 1, v24
    s_cbranch_vccz Lppd_13
    buffer_load_dwordx4 v[32:35], v164, s[40:43], 0 offen sc1
    s_waitcnt vmcnt(2)
    v_xor_b32 v24, s37, v37
    v_xor_b32 v25, s37, v39
    v_or_b32 v24, v24, v25
    v_cmp_lt_u32 vcc, 1, v24
    s_cbranch_vccz Lppd_14
    buffer_load_dwordx4 v[36:39], v164, s[40:43], 0 offen sc1
    s_waitcnt vmcnt(2)
    v_xor_b32 v24, s37, v41
    v_xor_b32 v25, s37, v43
    v_or_b32 v24, v24, v25
    v_cmp_lt_u32 vcc, 1, v24
    s_cbranch_vccz Lppd_15
    buffer_load_dwordx4 v[40:43], v164, s[40:43], 0 offen sc1
    s_sub_u32 s39, s39, 1
    s_cbranch_scc0 Lpp_11
    s_waitcnt vmcnt(0)
Lppd_13:
    v_mov_b32 v33, v34
    ds_write_b64 v5, v[32:33]
    s_branch Lppx_12
Lppd_14:
    v_mov_b32 v37, v38
    ds_write_b64 v5, v[36:37]
    s_branch Lppx_12
Lppd_15:
    v_mov_b32 v41, v42
    ds_write_b64 v5, v[40:41]
Lppx_12:
    v_mov_b32 v1, 1
    s_mov_b64 exec, 1
    ds_add_u32 v167, v1 offset:0
    s_mov_b64 exec, -1
    v_and_b32 v24, 1, v24
    s_nop 0
    v_readfirstlane_b32 s73, v24
    s_mov_b32 s39, 320000
Lw_16:
    ds_read_b32 v1, v167 offset:0
    s_sub_u32 s39, s39, 1
    s_cbranch_scc1 Lwx_17
    s_waitcnt lgkmcnt(0)
    v_readfirstlane_b32 s54, v1
    s_nop 0
    s_cmp_lt_u32 s54, 4
    s_cbranch_scc1 Lw_16
Lwx_17:
    s_waitcnt lgkmcnt(0)
    ds_read_b128 v[8:11], v4
    s_waitcnt lgkmcnt(0)
    v_mfma_f32_16x16x32_bf16 v[128:131], v[8:11], v[96:99], 0
    v_mfma_f32_16x16x32_bf16 v[132:135], v[8:11], v[100:103], 0
    v_mfma_f32_16x16x32_bf16 v[136:139], v[8:11], v[104:107], 0
    v_mfma_f32_16x16x32_bf16 v[140:143], v[8:11], v[108:111], 0
    v_mfma_f32_16x16x32_bf16 v[144:147], v[8:11], v[112:115], 0
    v_mfma_f32_16x16x32_bf16 v[148:151], v[8:11], v[116:119], 0
    v_mfma_f32_16x16x32_bf16 v[152:155], v[8:11], v[120:123], 0
    v_mfma_f32_16x16x32_bf16 v[156:159], v[8:11], v[124:127], 0
    s_mov_b64 exec, s[70:71]
    ds_write_b128 v165, v[128:131] offset:0
    ds_write_b128 v165, v[132:135] offset:128
    ds_write_b128 v165, v[136:139] offset:256
    ds_write_b128 v165, v[140:143] offset:384
    ds_write_b128 v165, v[144:147] offset:512
    ds_write_b128 v165, v[148:151] offset:640
    ds_write_b128 v165, v[152:155] offset:768
    ds_write_b128 v165, v[156:159] offset:896
    s_mov_b64 exec, -1
    v_mov_b32 v1, 1
    s_mov_b64 exec, 1
    ds_add_u32 v167, v1 offset:4
    s_mov_b64 exec, -1
    s_cmp_lg_u32 s73, 0
    s_cselect_b32 s66, 0x55555555, 0
    s_cselect_b32 s67, 0x55555555, 0
    s_cselect_b32 s68, 0, 0x55555555
    s_cselect_b32 s69, 0, 0x55555555
    s_add_u32 s55, s37, s73
    v_mov_b32 v17, s55
    v_mov_b32 v19, s55
    s_mov_b32 s39, 320000
Lw_18:
    ds_read_b32 v1, v167 offset:4
    s_sub_u32 s39, s39, 1
    s_cbranch_scc1 Lwx_19
    s_waitcnt lgkmcnt(0)
    v_readfirstlane_b32 s54, v1
    s_nop 0
    s_cmp_lt_u32 s54, 4
    s_cbranch_scc1 Lw_18
Lwx_19:
    s_waitcnt lgkmcnt(0)
    ds_read_b128 v[8:11], v6
    ds_read_b128 v[12:15], v6 offset:1040
    s_waitcnt lgkmcnt(0)
    v_pk_add_f32 v[8:9], v[8:9], v[12:13]
    v_pk_add_f32 v[10:11], v[10:11], v[14:15]
    s_nop 1
    v_permlane32_swap_b32 v8, v10
    v_permlane32_swap_b32 v9, v11
    v_add_f32 v8, v8, v10
    v_add_f32 v9, v9, v11
    s_nop 1
    v_permlane16_swap_b32 v8, v9
    v_add_f32 v8, v8, v9
    v_mov_b32 v16, v8
    s_nop 0
    v_mov_b32_dpp v18, v8 quad_perm:[1,1,3,3] row_mask:0xf bank_mask:0xf
    s_mov_b64 exec, s[66:67]
    buffer_store_dwordx4 v[16:19], v7, s[40:43], 0 offen
    s_mov_b64 exec, s[68:69]
    buffer_store_dwordx4 v[16:19], v7, s[40:43], 0 offen sc1
    s_mov_b64 exec, -1
L_pubd:
    v_mov_b32 v1, 1
    s_mov_b64 exec, 1
    ds_add_u32 v167, v1 offset:24
    s_mov_b64 exec, -1
L_qp:
    s_mov_b32 s100, 1835008
    s_lshl_b32 s101, s35, 16
    s_add_u32 s100, s100, s101
    s_lshl_b32 s101, s33, 12
    s_add_u32 s100, s100, s101
    s_lshl_b32 s101, s32, 10
    s_add_u32 s100, s100, s101
    v_lshl_add_u32 v4, v0, 4, s100
    s_mov_b32 s100, 256
    s_lshl_b32 s101, s32, 8
    s_add_u32 s100, s100, s101
    v_lshl_add_u32 v6, v0, 2, s100
    s_mov_b32 s56, 32768
    s_mov_b32 s39, 320000
Lw_20:
    ds_read_b32 v1, v167 offset:20
    s_sub_u32 s39, s39, 1
    s_cbranch_scc1 Lwx_21
    s_sleep 4
    s_waitcnt lgkmcnt(0)
    v_readfirstlane_b32 s54, v1
    s_nop 0
    s_cmp_lt_u32 s54, 1
    s_cbranch_scc1 Lw_20
Lwx_21:
    s_waitcnt lgkmcnt(0)
    s_mov_b32 s39, 40000
    buffer_load_dwordx4 v[128:131], v4, s[40:43], 0 offen sc1
    buffer_load_dwordx4 v[132:135], v4, s[40:43], s56 offen sc1
    s_sleep 14
    buffer_load_dwordx4 v[136:139], v4, s[40:43], 0 offen sc1
    buffer_load_dwordx4 v[140:143], v4, s[40:43], s56 offen sc1
Lpp_22:
    s_waitcnt vmcnt(2)
    s_nop 0
    v_xor_b32 v24, s37, v129
    v_xor_b32 v25, s37, v131
    v_or_b32 v24, v24, v25
    v_xor_b32 v25, s37, v133
    v_or_b32 v24, v24, v25
    v_xor_b32 v25, s37, v135
    v_or_b32 v24, v24, v25
    v_cmp_lt_u32 vcc, 1, v24
    s_cbranch_vccz Lppd_24
    buffer_load_dwordx4 v[128:131], v4, s[40:43], 0 offen sc1
    buffer_load_dwordx4 v[132:135], v4, s[40:43], s56 offen sc1
    s_waitcnt vmcnt(2)
    v_xor_b32 v24, s37, v137
    v_xor_b32 v25, s37, v139
    v_or_b32 v24, v24, v25
    v_xor_b32 v25, s37, v141
    v_or_b32 v24, v24, v25
    v_xor_b32 v25, s37, v143
    v_or_b32 v24, v24, v25
    v_cmp_lt_u32 vcc, 1, v24
    s_cbranch_vccz Lppd_25
    buffer_load_dwordx4 v[136:139], v4, s[40:43], 0 offen sc1
    buffer_load_dwordx4 v[140:143], v4, s[40:43], s56 offen sc1
    s_sub_u32 s39, s39, 1
    s_cbranch_scc0 Lpp_22
    s_waitcnt vmcnt(0)
Lppd_24:
    v_add_f32 v12, v128, v132
    v_add_f32 v13, v130, v134
    s_branch Lppx_23
Lppd_25:
    v_add_f32 v12, v136, v140
    v_add_f32 v13, v138, v142
Lppx_23:
    v_and_b32 v24, 1, v24
    v_cvt_pk_bf16_f32 v12, v12, v13
    ds_write_b32 v167, v24 offset:128
    ds_write_b32 v6, v12
    v_readfirstlane_b32 s73, v24
    v_mov_b32 v1, 1
    s_mov_b64 exec, 1
    ds_add_u32 v167, v1 offset:8
    s_mov_b64 exec, -1
    s_mul_i32 s9, s38, 0x01010101
    s_add_u32 s9, s9, 0x5B3C1E87
    s_and_b32 s6, s9, 0xff
    s_bfe_u32 s7, s9, 0x80008
    s_bfe_u32 s8, s9, 0x80010
    s_lshr_b32 s9, s9, 24
    s_cmp_lt_u32 s29, 16
    s_cbranch_scc1 L_Rpre
    s_cmp_lt_u32 s34, 4
    s_cbranch_scc1 L_S
    s_sub_u32 s3, s34, 20
    s_bitcmp1_b32 s33, 0
    s_cselect_b32 s55, 6, 8
    s_cselect_b32 s56, 1, 0
    s_cmp_ge_u32 s3, s55
    s_waitcnt vmcnt(0)
    s_cbranch_scc1 L_fin2
    s_mul_i32 s54, s33, 7
    s_add_u32 s3, s3, s56
    s_add_u32 s3, s3, s54
    s_and_b32 s12, s3, 6
    s_cmp_eq_u32 s12, 6
    s_cselect_b32 s10, 1, 0
    s_and_b32 s10, s3, s10
    s_xor_b32 s11, s10, 1
    s_and_b32 s56, s32, 1
    s_lshr_b32 s57, s32, 1
    s_cmp_eq_u32 s56, 0
    s_cselect_b32 s44, s16, s18
    s_cselect_b32 s45, s17, s19
    s_mov_b32 s46, 1835008
    s_mov_b32 s47, 0x20000
    s_mov_b32 s50, 1835008
    s_mov_b32 s51, 0x20000
    s_mov_b64 s[48:49], s[20:21]
    s_mul_i32 s100, s57, 917504
    s_lshl_b32 s101, s3, 6
    s_add_u32 s100, s100, s101
    s_mul_i32 s101, s10, 458752
    s_add_u32 s100, s100, s101
    v_lshrrev_b32 v1, 2, v0
    v_mul_u32_u24 v1, 28672, v1
    v_add_u32 v2, s100, v1
    v_and_b32 v1, 3, v0
    v_lshl_add_u32 v2, v1, 4, v2
    s_lshl_b32 s100, s3, 15
    s_lshl_b32 s101, s32, 8
    s_add_u32 s100, s100, s101
    v_lshrrev_b32 v1, 4, v0
    v_lshl_add_u32 v3, v1, 13, s100
    v_and_b32 v1, 15, v0
    v_lshl_add_u32 v3, v1, 4, v3
    s_mul_i32 s100, s57, 917504
    s_lshl_b32 s101, s3, 6
    s_add_u32 s100, s100, s101
    s_mul_i32 s101, s11, 458752
    s_add_u32 s100, s100, s101
    v_lshrrev_b32 v1, 2, v0
    v_mul_u32_u24 v1, 28672, v1
    v_add_u32 v161, s100, v1
    v_and_b32 v1, 3, v0
    v_lshl_add_u32 v161, v1, 4, v161
    s_mov_b32 s100, 2048
    s_lshl_b32 s101, s57, 9
    s_add_u32 s100, s100, s101
    s_lshl_b32 s101, s11, 8
    s_add_u32 s100, s100, s101
    v_and_b32 v1, 3, v0
    v_mul_u32_u24 v1, 1088, v1
    v_add_u32 v162, s100, v1
    v_bfe_u32 v1, v0, 2, 2
    v_lshl_add_u32 v162, v1, 4, v162
    v_lshrrev_b32 v1, 4, v0
    v_lshl_add_u32 v162, v1, 6, v162
    s_mov_b32 s100, 2048
    s_lshl_b32 s101, s57, 9
    s_add_u32 s100, s100, s101
    s_lshl_b32 s101, s10, 8
    s_add_u32 s100, s100, s101
    v_and_b32 v1, 3, v0
    v_mul_u32_u24 v1, 1088, v1
    v_add_u32 v4, s100, v1
    v_bfe_u32 v1, v0, 2, 2
    v_lshl_add_u32 v4, v1, 4, v4
    v_lshrrev_b32 v1, 4, v0
    v_lshl_add_u32 v4, v1, 6, v4
    s_mov_b32 s100, 6656
    s_mul_i32 s101, s57, 4160
    s_add_u32 s100, s100, s101
    s_lshl_b32 s101, s56, 9
    s_add_u32 s100, s100, s101
    v_bfe_u32 v1, v0, 2, 2
    v_mul_u32_u24 v1, 1040, v1
    v_add_u32 v5, s100, v1
    v_and_b32 v1, 3, v0
    v_lshl_add_u32 v5, v1, 4, v5
    s_mov_b32 s100, 6656
    s_lshl4_add_u32 s100, s32, s100
    v_lshrrev_b32 v1, 4, v0
    v_mul_u32_u24 v1, 2080, v1
    v_add_u32 v6, s100, v1
    v_and_b32 v1, 15, v0
    v_lshl_add_u32 v6, v1, 6, v6
    s_mov_b32 s100, 1441792
    s_lshl_b32 s101, s33, 13
    s_add_u32 s100, s100, s101
    s_lshl_b32 s101, s32, 11
    s_add_u32 s100, s100, s101
    v_lshl_add_u32 v7, v0, 4, s100
    s_mov_b32 s100, 2048
    s_mul_i32 s101, s32, 1088
    s_add_u32 s100, s100, s101
    v_lshl_add_u32 v144, v0, 3, s100
    s_mov_b32 s100, 1536
    s_lshl4_add_u32 s100, s32, s100
    v_lshrrev_b32 v1, 4, v0
    v_lshl_add_u32 v145, v1, 6, s100
    v_and_b32 v1, 7, v0
    v_lshl_add_u32 v145, v1, 1, v145
    s_mov_b32 s100, 1536
    v_and_b32 v1, 3, v0
    v_lshl_add_u32 v151, v1, 6, s100
    v_lshrrev_b32 v1, 4, v0
    v_lshl_add_u32 v151, v1, 4, v151
    v_mov_b32 v150, 64
    v_mov_b32 v160, 0xff
    v_bfe_u32 v8, v0, 2, 2
    v_cmp_eq_u32 vcc, 0, v8
    s_nop 1
    v_cndmask_b32 v146, v150, v151, vcc
    v_cmp_eq_u32 vcc, 1, v8
    s_nop 1
    v_cndmask_b32 v147, v150, v151, vcc
    v_cmp_eq_u32 vcc, 2, v8
    s_nop 1
    v_cndmask_b32 v148, v150, v151, vcc
    v_cmp_eq_u32 vcc, 3, v8
    s_nop 1
    v_cndmask_b32 v149, v150, v151, vcc
    s_mov_b32 s100, 983040
    s_lshl_b32 s101, s3, 13
    s_add_u32 s100, s100, s101
    s_lshl_b32 s101, s32, 11
    s_add_u32 s100, s100, s101
    v_and_b32 v1, 15, v0
    v_lshl_add_u32 v150, v1, 6, s100
    v_lshrrev_b32 v1, 4, v0
    v_lshl_add_u32 v150, v1, 4, v150
    s_mov_b32 s100, 3145728
    s_lshl_b32 s101, s33, 14
    s_add_u32 s100, s100, s101
    s_lshl_b32 s101, s32, 12
    s_add_u32 s100, s100, s101
    v_lshl_add_u32 v151, v0, 4, s100
    s_mov_b32 s70, 0x00f0000f
    s_mov_b32 s71, 0xf0000f00
    s_mov_b32 s39, 320000
Lw_26:
    ds_read_b32 v1, v167 offset:12
    s_sub_u32 s39, s39, 1
    s_cbranch_scc1 Lwx_27
    s_sleep 2
    s_waitcnt lgkmcnt(0)
    v_readfirstlane_b32 s54, v1
    s_nop 0
    s_cmp_lt_u32 s54, 8
    s_cbranch_scc1 Lw_26
Lwx_27:
    s_waitcnt lgkmcnt(0)
    buffer_load_dwordx4 v[96:99], v3, s[48:51], 0 offen offset:0 nt
    buffer_load_dwordx4 v[100:103], v3, s[48:51], 0 offen offset:1024 nt
    buffer_load_dwordx4 v[104:107], v3, s[48:51], 0 offen offset:2048 nt
    buffer_load_dwordx4 v[108:111], v3, s[48:51], 0 offen offset:3072 nt
    s_mov_b32 s54, 4096
    buffer_load_dwordx4 v[112:115], v3, s[48:51], s54 offen offset:0 nt
    buffer_load_dwordx4 v[116:119], v3, s[48:51], s54 offen offset:1024 nt
    buffer_load_dwordx4 v[120:123], v3, s[48:51], s54 offen offset:2048 nt
    buffer_load_dwordx4 v[124:127], v3, s[48:51], s54 offen offset:3072 nt
    s_mov_b32 s39, 320000
Lw_28:
    ds_read_b32 v1, v167 offset:16
    s_sub_u32 s39, s39, 1
    s_cbranch_scc1 Lwx_29
    s_sleep 1
    s_waitcnt lgkmcnt(0)
    v_readfirstlane_b32 s54, v1
    s_nop 0
    s_cmp_lt_u32 s54, 8
    s_cbranch_scc1 Lw_28
Lwx_29:
    s_waitcnt lgkmcnt(0)
    s_cmp_eq_u32 s12, 6
    s_cbranch_scc0 L_fnt
    buffer_load_dwordx4 v[32:35], v2, s[44:47], 0 offen offset:0
    buffer_load_dwordx4 v[36:39], v2, s[44:47], 0 offen offset:3584
    s_mov_b32 s54, 4096
    buffer_load_dwordx4 v[40:43], v2, s[44:47], s54 offen offset:3072
    s_mov_b32 s54, 8192
    buffer_load_dwordx4 v[44:47], v2, s[44:47], s54 offen offset:2560
    s_mov_b32 s54, 12288
    buffer_load_dwordx4 v[48:51], v2, s[44:47], s54 offen offset:2048
    s_mov_b32 s54, 16384
    buffer_load_dwordx4 v[52:55], v2, s[44:47], s54 offen offset:1536
    s_mov_b32 s54, 20480
    buffer_load_dwordx4 v[56:59], v2, s[44:47], s54 offen offset:1024
    s_mov_b32 s54, 24576
    buffer_load_dwordx4 v[60:63], v2, s[44:47], s54 offen offset:512
    s_branch L_f2
L_fnt:
    buffer_load_dwordx4 v[32:35], v2, s[44:47], 0 offen offset:0 nt
    buffer_load_dwordx4 v[36:39], v2, s[44:47], 0 offen offset:3584 nt
    s_mov_b32 s54, 4096
    buffer_load_dwordx4 v[40:43], v2, s[44:47], s54 offen offset:3072 nt
    s_mov_b32 s54, 8192
    buffer_load_dwordx4 v[44:47], v2, s[44:47], s54 offen offset:2560 nt
    s_mov_b32 s54, 12288
    buffer_load_dwordx4 v[48:51], v2, s[44:47], s54 offen offset:2048 nt
    s_mov_b32 s54, 16384
    buffer_load_dwordx4 v[52:55], v2, s[44:47], s54 offen offset:1536 nt
    s_mov_b32 s54, 20480
    buffer_load_dwordx4 v[56:59], v2, s[44:47], s54 offen offset:1024 nt
    s_mov_b32 s54, 24576
    buffer_load_dwordx4 v[60:63], v2, s[44:47], s54 offen offset:512 nt
L_f2:
    buffer_load_dwordx4 v[64:67], v161, s[44:47], 0 offen offset:0 nt
    buffer_load_dwordx4 v[68:71], v161, s[44:47], 0 offen offset:3584 nt
    s_mov_b32 s54, 4096
    buffer_load_dwordx4 v[72:75], v161, s[44:47], s54 offen offset:3072 nt
    s_mov_b32 s54, 8192
    buffer_load_dwordx4 v[76:79], v161, s[44:47], s54 offen offset:2560 nt
    s_mov_b32 s54, 12288
    buffer_load_dwordx4 v[80:83], v161, s[44:47], s54 offen offset:2048 nt
    s_mov_b32 s54, 16384
    buffer_load_dwordx4 v[84:87], v161, s[44:47], s54 offen offset:1536 nt
    s_mov_b32 s54, 20480
    buffer_load_dwordx4 v[88:91], v161, s[44:47], s54 offen offset:1024 nt
    s_mov_b32 s54, 24576
    buffer_load_dwordx4 v[92:95], v161, s[44:47], s54 offen offset:512 nt
    s_mov_b32 s39, 40000
    buffer_load_dwordx4 v[8:11], v151, s[40:43], 0 offen offset:0 sc1
    buffer_load_dwordx4 v[12:15], v151, s[40:43], 0 offen offset:1024 sc1
    buffer_load_dwordx4 v[16:19], v151, s[40:43], 0 offen offset:2048 sc1
    buffer_load_dwordx4 v[20:23], v151, s[40:43], 0 offen offset:3072 sc1
    s_waitcnt vmcnt(20)
    v_perm_b32 v1, v100, v96, s52
    v_perm_b32 v100, v100, v96, s53
    v_mov_b32 v96, v1
    v_perm_b32 v1, v101, v97, s52
    v_perm_b32 v2, v101, v97, s53
    v_perm_b32 v97, v108, v104, s52
    v_perm_b32 v101, v108, v104, s53
    v_mov_b32 v104, v1
    v_mov_b32 v108, v2
    v_perm_b32 v1, v102, v98, s52
    v_perm_b32 v2, v102, v98, s53
    v_perm_b32 v98, v116, v112, s52
    v_perm_b32 v102, v116, v112, s53
    v_mov_b32 v112, v1
    v_mov_b32 v116, v2
    v_perm_b32 v1, v103, v99, s52
    v_perm_b32 v2, v103, v99, s53
    v_perm_b32 v99, v124, v120, s52
    v_perm_b32 v103, v124, v120, s53
    v_mov_b32 v120, v1
    v_mov_b32 v124, v2
    v_perm_b32 v1, v109, v105, s52
    v_perm_b32 v109, v109, v105, s53
    v_mov_b32 v105, v1
    v_perm_b32 v1, v110, v106, s52
    v_perm_b32 v2, v110, v106, s53
    v_perm_b32 v106, v117, v113, s52
    v_perm_b32 v110, v117, v113, s53
    v_mov_b32 v113, v1
    v_mov_b32 v117, v2
    v_perm_b32 v1, v111, v107, s52
    v_perm_b32 v2, v111, v107, s53
    v_perm_b32 v107, v125, v121, s52
    v_perm_b32 v111, v125, v121, s53
    v_mov_b32 v121, v1
    v_mov_b32 v125, v2
    v_perm_b32 v1, v118, v114, s52
    v_perm_b32 v118, v118, v114, s53
    v_mov_b32 v114, v1
    v_perm_b32 v1, v119, v115, s52
    v_perm_b32 v2, v119, v115, s53
    v_perm_b32 v115, v126, v122, s52
    v_perm_b32 v119, v126, v122, s53
    v_mov_b32 v122, v1
    v_mov_b32 v126, v2
    v_perm_b32 v1, v127, v123, s52
    v_perm_b32 v127, v127, v123, s53
    v_mov_b32 v123, v1
    s_waitcnt vmcnt(12)
    v_perm_b32 v1, v36, v32, s52
    v_perm_b32 v36, v36, v32, s53
    v_mov_b32 v32, v1
    v_perm_b32 v1, v37, v33, s52
    v_perm_b32 v2, v37, v33, s53
    v_perm_b32 v33, v44, v40, s52
    v_perm_b32 v37, v44, v40, s53
    v_mov_b32 v40, v1
    v_mov_b32 v44, v2
    v_perm_b32 v1, v38, v34, s52
    v_perm_b32 v2, v38, v34, s53
    v_perm_b32 v34, v52, v48, s52
    v_perm_b32 v38, v52, v48, s53
    v_mov_b32 v48, v1
    v_mov_b32 v52, v2
    v_perm_b32 v1, v39, v35, s52
    v_perm_b32 v2, v39, v35, s53
    v_perm_b32 v35, v60, v56, s52
    v_perm_b32 v39, v60, v56, s53
    v_mov_b32 v56, v1
    v_mov_b32 v60, v2
    v_perm_b32 v1, v45, v41, s52
    v_perm_b32 v45, v45, v41, s53
    v_mov_b32 v41, v1
    v_perm_b32 v1, v46, v42, s52
    v_perm_b32 v2, v46, v42, s53
    v_perm_b32 v42, v53, v49, s52
    v_perm_b32 v46, v53, v49, s53
    v_mov_b32 v49, v1
    v_mov_b32 v53, v2
    v_perm_b32 v1, v47, v43, s52
    v_perm_b32 v2, v47, v43, s53
    v_perm_b32 v43, v61, v57, s52
    v_perm_b32 v47, v61, v57, s53
    v_mov_b32 v57, v1
    v_mov_b32 v61, v2
    v_perm_b32 v1, v54, v50, s52
    v_perm_b32 v54, v54, v50, s53
    v_mov_b32 v50, v1
    v_perm_b32 v1, v55, v51, s52
    v_perm_b32 v2, v55, v51, s53
    v_perm_b32 v51, v62, v58, s52
    v_perm_b32 v55, v62, v58, s53
    v_mov_b32 v58, v1
    v_mov_b32 v62, v2
    v_perm_b32 v1, v63, v59, s52
    v_perm_b32 v63, v63, v59, s53
    v_mov_b32 v59, v1
    s_waitcnt vmcnt(4)
    buffer_load_dwordx4 v[24:27], v7, s[40:43], 0 offen sc1
    buffer_load_dwordx4 v[28:31], v7, s[40:43], 0 offen offset:1024 sc1
    v_perm_b32 v1, v68, v64, s52
    v_perm_b32 v68, v68, v64, s53
    v_mov_b32 v64, v1
    v_perm_b32 v1, v69, v65, s52
    v_perm_b32 v2, v69, v65, s53
    v_perm_b32 v65, v76, v72, s52
    v_perm_b32 v69, v76, v72, s53
    v_mov_b32 v72, v1
    v_mov_b32 v76, v2
    v_perm_b32 v1, v70, v66, s52
    v_perm_b32 v2, v70, v66, s53
    v_perm_b32 v66, v84, v80, s52
    v_perm_b32 v70, v84, v80, s53
    v_mov_b32 v80, v1
    v_mov_b32 v84, v2
    v_perm_b32 v1, v71, v67, s52
    v_perm_b32 v2, v71, v67, s53
    v_perm_b32 v67, v92, v88, s52
    v_perm_b32 v71, v92, v88, s53
    v_mov_b32 v88, v1
    v_mov_b32 v92, v2
    v_perm_b32 v1, v77, v73, s52
    v_perm_b32 v77, v77, v73, s53
    v_mov_b32 v73, v1
    v_perm_b32 v1, v78, v74, s52
    v_perm_b32 v2, v78, v74, s53
    v_perm_b32 v74, v85, v81, s52
    v_perm_b32 v78, v85, v81, s53
    v_mov_b32 v81, v1
    v_mov_b32 v85, v2
    v_perm_b32 v1, v79, v75, s52
    v_perm_b32 v2, v79, v75, s53
    v_perm_b32 v75, v93, v89, s52
    v_perm_b32 v79, v93, v89, s53
    v_mov_b32 v89, v1
    v_mov_b32 v93, v2
    v_perm_b32 v1, v86, v82, s52
    v_perm_b32 v86, v86, v82, s53
    v_mov_b32 v82, v1
    v_perm_b32 v1, v87, v83, s52
    v_perm_b32 v2, v87, v83, s53
    v_perm_b32 v83, v94, v90, s52
    v_perm_b32 v87, v94, v90, s53
    v_mov_b32 v90, v1
    v_mov_b32 v94, v2
    v_perm_b32 v1, v95, v91, s52
    v_perm_b32 v95, v95, v91, s53
    v_mov_b32 v91, v1
    s_waitcnt vmcnt(2)
    s_branch Lptc_32
Lpt_30:
    buffer_load_dwordx4 v[8:11], v151, s[40:43], 0 offen offset:0 sc1
    buffer_load_dwordx4 v[12:15], v151, s[40:43], 0 offen offset:1024 sc1
    buffer_load_dwordx4 v[16:19], v151, s[40:43], 0 offen offset:2048 sc1
    buffer_load_dwordx4 v[20:23], v151, s[40:43], 0 offen offset:3072 sc1
    s_sub_u32 s39, s39, 1
    s_waitcnt vmcnt(0)
    s_cbranch_scc1 Lptx_31
Lptc_32:
    s_nop 1
    v_cmp_ne_u32 vcc, s37, v9
    v_cmp_ne_u32 s[54:55], s37, v11
    s_nop 0
    s_or_b64 vcc, vcc, s[54:55]
    v_cmp_ne_u32 s[54:55], s37, v13
    s_nop 0
    s_or_b64 vcc, vcc, s[54:55]
    v_cmp_ne_u32 s[54:55], s37, v15
    s_nop 0
    s_or_b64 vcc, vcc, s[54:55]
    v_cmp_ne_u32 s[54:55], s37, v17
    s_nop 0
    s_or_b64 vcc, vcc, s[54:55]
    v_cmp_ne_u32 s[54:55], s37, v19
    s_nop 0
    s_or_b64 vcc, vcc, s[54:55]
    v_cmp_ne_u32 s[54:55], s37, v21
    s_nop 0
    s_or_b64 vcc, vcc, s[54:55]
    v_cmp_ne_u32 s[54:55], s37, v23
    s_nop 0
    s_or_b64 vcc, vcc, s[54:55]
    s_cbranch_scc1 Lpt_30
Lptx_31:
    v_lshlrev_b32 v136, 16, v8
    s_nop 0
    v_and_b32 v137, s72, v8
    v_lshlrev_b32 v128, 16, v10
    v_and_b32 v129, s72, v10
    v_lshlrev_b32 v138, 16, v12
    v_and_b32 v139, s72, v12
    v_lshlrev_b32 v130, 16, v14
    v_and_b32 v131, s72, v14
    v_lshlrev_b32 v140, 16, v16
    v_and_b32 v141, s72, v16
    v_lshlrev_b32 v132, 16, v18
    v_and_b32 v133, s72, v18
    v_lshlrev_b32 v142, 16, v20
    v_and_b32 v143, s72, v20
    v_lshlrev_b32 v134, 16, v22
    v_and_b32 v135, s72, v22
    s_mov_b32 s39, 40000
    s_waitcnt vmcnt(0)
    s_branch Lptc_35
Lpt_33:
    buffer_load_dwordx4 v[24:27], v7, s[40:43], 0 offen sc1
    buffer_load_dwordx4 v[28:31], v7, s[40:43], 0 offen offset:1024 sc1
    s_sub_u32 s39, s39, 1
    s_waitcnt vmcnt(0)
    s_cbranch_scc1 Lptx_34
Lptc_35:
    s_nop 1
    v_cmp_ne_u32 vcc, s37, v25
    v_cmp_ne_u32 s[54:55], s37, v27
    s_nop 0
    s_or_b64 vcc, vcc, s[54:55]
    v_cmp_ne_u32 s[54:55], s37, v29
    s_nop 0
    s_or_b64 vcc, vcc, s[54:55]
    v_cmp_ne_u32 s[54:55], s37, v31
    s_nop 0
    s_or_b64 vcc, vcc, s[54:55]
    s_cbranch_scc1 Lpt_33
Lptx_34:
    v_lshlrev_b32 v152, 16, v24
    s_nop 0
    v_and_b32 v153, s72, v24
    v_lshlrev_b32 v154, 16, v26
    v_and_b32 v155, s72, v26
    v_lshlrev_b32 v156, 16, v28
    v_and_b32 v157, s72, v28
    v_lshlrev_b32 v158, 16, v30
    v_and_b32 v159, s72, v30
    v_readfirstlane_b32 s100, v152
    s_nop 1
    v_pk_add_f32 v[152:153], v[152:153], s[100:101] op_sel_hi:[1,0] neg_lo:[0,1] neg_hi:[0,1]
    v_pk_add_f32 v[154:155], v[154:155], s[100:101] op_sel_hi:[1,0] neg_lo:[0,1] neg_hi:[0,1]
    v_pk_add_f32 v[156:157], v[156:157], s[100:101] op_sel_hi:[1,0] neg_lo:[0,1] neg_hi:[0,1]
    v_pk_add_f32 v[158:159], v[158:159], s[100:101] op_sel_hi:[1,0] neg_lo:[0,1] neg_hi:[0,1]
    v_pk_add_f32 v[16:17], v[152:153], v[154:155]
    v_pk_mul_f32 v[18:19], v[152:153], v[152:153]
    v_pk_fma_f32 v[18:19], v[154:155], v[154:155], v[18:19]
    v_pk_add_f32 v[20:21], v[156:157], v[158:159]
    v_pk_fma_f32 v[18:19], v[156:157], v[156:157], v[18:19]
    v_pk_add_f32 v[16:17], v[16:17], v[20:21]
    v_pk_fma_f32 v[18:19], v[158:159], v[158:159], v[18:19]
    v_add_f32 v16, v16, v17
    v_add_f32 v18, v18, v19
    v_mov_b32 v20, 0x3b000000
    v_mov_b32 v21, 0x3727c5ac
    v_permlane32_swap_b32 v16, v18
    v_add_f32 v16, v16, v18
    s_nop 1
    v_add_f32_dpp v16, v16, v16 quad_perm:[1,0,3,2] row_mask:0xf bank_mask:0xf
    s_nop 1
    v_add_f32_dpp v16, v16, v16 quad_perm:[2,3,0,1] row_mask:0xf bank_mask:0xf
    s_nop 1
    v_add_f32_dpp v16, v16, v16 row_half_mirror row_mask:0xf bank_mask:0xf
    s_nop 1
    v_add_f32_dpp v16, v16, v16 row_mirror row_mask:0xf bank_mask:0xf
    s_nop 0
    v_readlane_b32 s54, v16, 0
    v_readlane_b32 s55, v16, 16
    v_readlane_b32 s56, v16, 32
    v_readlane_b32 s57, v16, 48
    v_mul_f32 v16, s54, v20
    v_mul_f32 v18, s56, v20
    v_fmac_f32 v16, s55, v20
    v_fmac_f32 v18, s57, v20
    v_fma_f32 v18, -v16, v16, v18
    v_max_f32 v18, 0, v18
    v_add_f32 v18, v21, v18
    v_rsq_f32 v18, v18
    v_pk_add_f32 v[152:153], v[152:153], v[16:17] op_sel_hi:[1,0] neg_lo:[0,1] neg_hi:[0,1]
    v_pk_add_f32 v[154:155], v[154:155], v[16:17] op_sel_hi:[1,0] neg_lo:[0,1] neg_hi:[0,1]
    v_pk_add_f32 v[156:157], v[156:157], v[16:17] op_sel_hi:[1,0] neg_lo:[0,1] neg_hi:[0,1]
    v_pk_add_f32 v[158:159], v[158:159], v[16:17] op_sel_hi:[1,0] neg_lo:[0,1] neg_hi:[0,1]
    v_pk_mul_f32 v[128:129], v[128:129], v[18:19] op_sel_hi:[1,0]
    v_pk_mul_f32 v[130:131], v[130:131], v[18:19] op_sel_hi:[1,0]
    v_pk_mul_f32 v[132:133], v[132:133], v[18:19] op_sel_hi:[1,0]
    v_pk_mul_f32 v[134:135], v[134:135], v[18:19] op_sel_hi:[1,0]
    v_pk_fma_f32 v[152:153], v[152:153], v[128:129], v[136:137]
    v_pk_fma_f32 v[154:155], v[154:155], v[130:131], v[138:139]
    v_pk_fma_f32 v[156:157], v[156:157], v[132:133], v[140:141]
    v_pk_fma_f32 v[158:159], v[158:159], v[134:135], v[142:143]
    v_cvt_pk_bf16_f32 v12, v152, v153
    v_cvt_pk_bf16_f32 v13, v154, v155
    v_cvt_pk_bf16_f32 v14, v156, v157
    v_cvt_pk_bf16_f32 v15, v158, v159
    ds_write_b64 v144, v[12:13]
    ds_write_b64 v144, v[14:15] offset:512
    s_waitcnt lgkmcnt(0)
    s_barrier
    ds_read_b128 v[8:11], v4
    ds_read_b128 v[12:15], v162
    s_waitcnt lgkmcnt(1)
    v_mfma_f32_16x16x32_bf16 v[128:131], v[8:11], v[32:35], 0
    v_mfma_f32_16x16x32_bf16 v[132:135], v[8:11], v[36:39], 0
    v_mfma_f32_16x16x32_bf16 v[136:139], v[8:11], v[40:43], 0
    v_mfma_f32_16x16x32_bf16 v[140:143], v[8:11], v[44:47], 0
    v_mfma_f32_16x16x32_bf16 v[16:19], v[8:11], v[48:51], 0
    v_mfma_f32_16x16x32_bf16 v[20:23], v[8:11], v[52:55], 0
    v_mfma_f32_16x16x32_bf16 v[24:27], v[8:11], v[56:59], 0
    v_mfma_f32_16x16x32_bf16 v[28:31], v[8:11], v[60:63], 0
    s_waitcnt lgkmcnt(0)
    s_mov_b64 exec, s[70:71]
    v_mfma_f32_16x16x32_bf16 v[128:131], v[12:15], v[64:67], v[128:131]
    v_mfma_f32_16x16x32_bf16 v[132:135], v[12:15], v[68:71], v[132:135]
    v_mfma_f32_16x16x32_bf16 v[136:139], v[12:15], v[72:75], v[136:139]
    v_mfma_f32_16x16x32_bf16 v[140:143], v[12:15], v[76:79], v[140:143]
    s_nop 4
    ds_write_b128 v5, v[128:131] offset:0
    v_mfma_f32_16x16x32_bf16 v[16:19], v[12:15], v[80:83], v[16:19]
    ds_write_b128 v5, v[132:135] offset:64
    v_mfma_f32_16x16x32_bf16 v[20:23], v[12:15], v[84:87], v[20:23]
    ds_write_b128 v5, v[136:139] offset:128
    v_mfma_f32_16x16x32_bf16 v[24:27], v[12:15], v[88:91], v[24:27]
    ds_write_b128 v5, v[140:143] offset:192
    v_mfma_f32_16x16x32_bf16 v[28:31], v[12:15], v[92:95], v[28:31]
    s_nop 1
    ds_write_b128 v5, v[16:19] offset:256
    s_nop 0
    ds_write_b128 v5, v[20:23] offset:320
    s_nop 0
    ds_write_b128 v5, v[24:27] offset:384
    s_nop 0
    ds_write_b128 v5, v[28:31] offset:448
    s_mov_b64 exec, -1
    s_waitcnt lgkmcnt(0)
    s_barrier
    ds_read_b128 v[8:11], v6
    ds_read_b128 v[12:15], v6 offset:1040
    s_waitcnt lgkmcnt(0)
    v_pk_add_f32 v[8:9], v[8:9], v[12:13]
    v_pk_add_f32 v[10:11], v[10:11], v[14:15]
    s_nop 1
    v_permlane32_swap_b32 v8, v10
    v_permlane32_swap_b32 v9, v11
    v_add_f32 v8, v8, v10
    v_add_f32 v9, v9, v11
    s_nop 1
    v_permlane16_swap_b32 v8, v9
    v_add_f32 v8, v8, v9
    v_mov_b32 v11, 0x3d372713
    v_mul_f32 v10, v8, v8
    v_mov_b32_dpp v9, v8 row_ror:8 row_mask:0xf bank_mask:0xf
    v_fma_f32 v10, v10, v11, 1.0
    v_mul_f32 v10, v10, v8
    v_mul_f32 v10, 0xc0135761, v10
    v_exp_f32 v10, v10
    s_nop 0
    v_add_f32 v10, 1.0, v10
    v_rcp_f32 v10, v10
    v_mul_f32 v8, v8, v9
    v_mul_f32 v8, v8, v10
    v_cvt_pk_bf16_f32 v8, v8, v8
    s_mov_b32 exec_lo, 0x00ff00ff
    s_mov_b32 exec_hi, 0x00ff00ff
    ds_write_b16 v145, v8
    s_mov_b64 exec, -1
    s_waitcnt lgkmcnt(0)
    s_barrier
    ds_read_b128 v[8:11], v146
    ds_read_b128 v[12:15], v147
    ds_read_b128 v[16:19], v148
    ds_read_b128 v[20:23], v149
    s_waitcnt lgkmcnt(3)
    v_mfma_f32_16x16x32_bf16 v[128:131], v[8:11], v[96:99], 0
    v_mfma_f32_16x16x32_bf16 v[132:135], v[8:11], v[112:115], 0
    s_waitcnt lgkmcnt(2)
    v_mfma_f32_16x16x32_bf16 v[128:131], v[12:15], v[100:103], v[128:131]
    v_mfma_f32_16x16x32_bf16 v[132:135], v[12:15], v[116:119], v[132:135]
    s_waitcnt lgkmcnt(1)
    v_mfma_f32_16x16x32_bf16 v[128:131], v[16:19], v[104:107], v[128:131]
    v_mfma_f32_16x16x32_bf16 v[132:135], v[16:19], v[120:123], v[132:135]
    s_waitcnt lgkmcnt(0)
    v_mfma_f32_16x16x32_bf16 v[128:131], v[20:23], v[108:111], v[128:131]
    v_mfma_f32_16x16x32_bf16 v[132:135], v[20:23], v[124:127], v[132:135]
    s_nop 6
    v_bfi_b32 v128, v160, s6, v128
    v_bfi_b32 v129, v160, s7, v129
    v_bfi_b32 v130, v160, s8, v130
    v_bfi_b32 v131, v160, s9, v131
    buffer_store_dwordx4 v[128:131], v150, s[40:43], 0 offen sc1
    v_bfi_b32 v132, v160, s6, v132
    v_bfi_b32 v133, v160, s7, v133
    v_bfi_b32 v134, v160, s8, v134
    v_bfi_b32 v135, v160, s9, v135
    buffer_store_dwordx4 v[132:135], v150, s[40:43], 0 offen offset:1024 sc1
    s_branch L_fin2
L_S:
    s_mov_b32 s100, 1585152
    s_mul_i32 s101, s35, 24576
    s_add_u32 s100, s100, s101
    s_lshl_b32 s101, s32, 10
    s_add_u32 s100, s100, s101
    v_lshl_add_u32 v4, v0, 4, s100
    s_and_b32 s56, s32, 1
    s_lshr_b32 s57, s32, 1
    s_mov_b32 s100, 3145728
    s_lshl_b32 s101, s33, 14
    s_add_u32 s100, s100, s101
    s_lshl_b32 s101, s35, 12
    s_add_u32 s100, s100, s101
    s_lshl_b32 s101, s56, 9
    s_add_u32 s100, s100, s101
    s_lshl_b32 s101, s57, 11
    s_add_u32 s100, s100, s101
    v_and_b32 v1, 1, v0
    v_lshl_add_u32 v7, v1, 10, s100
    v_lshrrev_b32 v1, 1, v0
    v_lshl_add_u32 v7, v1, 4, v7
    s_cmp_lg_u32 s73, 0
    s_cselect_b32 s66, -1, 0
    s_cselect_b32 s67, -1, 0
    s_cselect_b32 s68, 0, -1
    s_cselect_b32 s69, 0, -1
    v_add_u32 v5, 4096, v4
    s_mov_b32 s56, 98304
    v_mov_b32 v17, s37
    v_mov_b32 v19, s37
    s_mov_b32 s39, 320000
Lw_36:
    ds_read_b32 v1, v167 offset:28
    s_sub_u32 s39, s39, 1
    s_cbranch_scc1 Lwx_37
    s_sleep 2
    s_waitcnt lgkmcnt(0)
    v_readfirstlane_b32 s54, v1
    s_nop 0
    s_cmp_lt_u32 s54, 8
    s_cbranch_scc1 Lw_36
Lwx_37:
    s_waitcnt lgkmcnt(0)
    s_mov_b32 s39, 40000
Lpt_38:
    buffer_load_dwordx4 v[32:35], v4, s[40:43], 0 offen sc1
    buffer_load_dwordx4 v[36:39], v4, s[40:43], s56 offen sc1
    buffer_load_dwordx4 v[40:43], v5, s[40:43], 0 offen sc1
    buffer_load_dwordx4 v[44:47], v5, s[40:43], s56 offen sc1
    s_sub_u32 s39, s39, 1
    s_waitcnt vmcnt(0)
    s_cbranch_scc1 Lptx_39
Lptc_40:
    s_nop 1
    v_cmp_ne_u32 vcc, s37, v33
    v_cmp_ne_u32 s[54:55], s37, v35
    s_nop 0
    s_or_b64 vcc, vcc, s[54:55]
    v_cmp_ne_u32 s[54:55], s37, v37
    s_nop 0
    s_or_b64 vcc, vcc, s[54:55]
    v_cmp_ne_u32 s[54:55], s37, v39
    s_nop 0
    s_or_b64 vcc, vcc, s[54:55]
    v_cmp_ne_u32 s[54:55], s37, v41
    s_nop 0
    s_or_b64 vcc, vcc, s[54:55]
    v_cmp_ne_u32 s[54:55], s37, v43
    s_nop 0
    s_or_b64 vcc, vcc, s[54:55]
    v_cmp_ne_u32 s[54:55], s37, v45
    s_nop 0
    s_or_b64 vcc, vcc, s[54:55]
    v_cmp_ne_u32 s[54:55], s37, v47
    s_nop 0
    s_or_b64 vcc, vcc, s[54:55]
    s_cbranch_scc1 Lpt_38
Lptx_39:
    v_add_f32 v8, v32, v36
    v_add_f32 v9, v34, v38
    v_add_f32 v10, v40, v44
    v_add_f32 v11, v42, v46
    v_cvt_pk_bf16_f32 v16, v8, v9
    v_cvt_pk_bf16_f32 v12, v10, v11
    v_lshlrev_b32 v10, 16, v12
    v_and_b32 v11, s72, v12
    v_add_f32 v10, 1.0, v10
    v_add_f32 v11, 1.0, v11
    v_cvt_pk_bf16_f32 v18, v10, v11
    s_mov_b64 exec, s[66:67]
    buffer_store_dwordx4 v[16:19], v7, s[40:43], 0 offen
    s_mov_b64 exec, s[68:69]
    buffer_store_dwordx4 v[16:19], v7, s[40:43], 0 offen sc1
    s_mov_b64 exec, -1
    s_branch L_fin2
L_Rpre:
    s_mov_b32 s50, 4096
    s_mov_b32 s51, 0x20000
    s_mov_b64 s[48:49], s[4:5]
    s_mov_b32 s46, 4194304
    s_mov_b32 s47, 0x20000
    s_mov_b64 s[44:45], s[12:13]
    s_and_b32 s55, s29, 3
    s_lshr_b32 s56, s29, 2
    s_bfe_u32 s57, s29, 0x10001
    s_xor_b32 s56, s56, s57
    s_mov_b32 s100, 655360
    s_lshl_b32 s101, s33, 11
    s_add_u32 s100, s100, s101
    s_lshl_b32 s101, s55, 9
    s_add_u32 s100, s100, s101
    v_and_b32 v1, 15, v0
    v_lshl_add_u32 v5, v1, 5, s100
    s_lshl_b32 s100, s33, 19
    s_lshl_b32 s101, s55, 17
    s_add_u32 s100, s100, s101
    s_lshl_b32 s101, s56, 8
    s_add_u32 s100, s100, s101
    s_lshl_b32 s101, s32, 11
    s_add_u32 s100, s100, s101
    v_bfe_u32 v1, v0, 4, 1
    v_lshl_add_u32 v2, v1, 16, s100
    v_lshrrev_b32 v1, 5, v0
    v_lshl_add_u32 v2, v1, 10, v2
    v_and_b32 v1, 15, v0
    v_lshl_add_u32 v2, v1, 4, v2
    s_mov_b32 s100, 131072
    s_lshl_b32 s101, s33, 16
    s_add_u32 s100, s100, s101
    s_lshl_b32 s101, s55, 14
    s_add_u32 s100, s100, s101
    s_lshl_b32 s101, s32, 9
    s_add_u32 s100, s100, s101
    v_bfe_u32 v1, v0, 2, 2
    v_lshl_add_u32 v4, v1, 12, s100
    v_lshrrev_b32 v1, 4, v0
    v_lshl_add_u32 v4, v1, 6, v4
    v_and_b32 v1, 3, v0
    v_lshl_add_u32 v4, v1, 4, v4
    s_mov_b32 s100, 33792
    s_mul_i32 s101, s32, 2304
    s_add_u32 s100, s100, s101
    v_and_b32 v1, 15, v0
    v_mul_u32_u24 v1, 144, v1
    v_add_u32 v6, s100, v1
    v_lshrrev_b32 v1, 4, v0
    v_lshl_add_u32 v6, v1, 4, v6
    s_mov_b32 s100, 33792
    s_mul_i32 s101, s32, 1152
    s_add_u32 s100, s100, s101
    v_lshrrev_b32 v1, 3, v0
    v_mul_u32_u24 v1, 144, v1
    v_add_u32 v7, s100, v1
    v_and_b32 v1, 7, v0
    v_lshl_add_u32 v7, v1, 4, v7
    s_mov_b32 s100, 720896
    s_lshl_b32 s101, s33, 15
    s_add_u32 s100, s100, s101
    s_lshl_b32 s101, s55, 13
    s_add_u32 s100, s100, s101
    s_lshl_b32 s101, s56, 11
    s_add_u32 s100, s100, s101
    s_lshl_b32 s101, s32, 10
    s_add_u32 s100, s100, s101
    v_lshl_add_u32 v3, v0, 4, s100
    s_lshl_b32 s100, s98, 4
    v_lshrrev_b32 v1, 4, v0
    v_lshl_add_u32 v21, v1, 10, s100
    v_and_b32 v1, 7, v0
    v_lshl_add_u32 v21, v1, 1, v21
    s_mov_b32 s100, 1581056
    s_lshl_b32 s101, s98, 6
    s_add_u32 s100, s100, s101
    v_lshrrev_b32 v1, 4, v0
    v_mul_u32_u24 v1, 24576, v1
    v_add_u32 v30, s100, v1
    v_bfe_u32 v1, v0, 3, 1
    v_mul_u32_u24 v1, 98304, v1
    v_add_u32 v30, v30, v1
    v_and_b32 v1, 7, v0
    v_lshl_add_u32 v30, v1, 3, v30
    s_and_b32 s57, s33, 1
    s_mov_b32 s100, 720896
    s_lshl_b32 s101, s98, 7
    s_add_u32 s100, s100, s101
    v_lshrrev_b32 v1, 3, v0
    v_lshl_add_u32 v163, v1, 13, s100
    v_and_b32 v1, 7, v0
    v_lshl_add_u32 v163, v1, 4, v163
    s_mov_b32 s100, 1441792
    s_lshl_b32 s101, s33, 13
    s_add_u32 s100, s100, s101
    s_lshl_b32 s101, s98, 5
    s_add_u32 s100, s100, s101
    v_lshrrev_b32 v1, 4, v0
    v_lshl_add_u32 v164, v1, 11, s100
    v_bfe_u32 v1, v0, 2, 1
    v_lshl_add_u32 v164, v1, 4, v164
    s_lshl_b32 s100, s98, 4
    s_lshl3_add_u32 s100, s57, s100
    v_lshrrev_b32 v1, 4, v0
    v_lshl_add_u32 v165, v1, 10, s100
    s_cmp_lg_u32 s73, 0
    s_cselect_b32 s66, 0x00110011, 0
    s_cselect_b32 s67, 0x00110011, 0
    s_cselect_b32 s68, 0, 0x00110011
    s_cselect_b32 s69, 0, 0x00110011
    s_movk_i32 s10, 12288
    s_mov_b32 s39, 320000
Lw_41:
    ds_read_b32 v1, v167 offset:12
    s_sub_u32 s39, s39, 1
    s_cbranch_scc1 Lwx_42
    s_sleep 2
    s_waitcnt lgkmcnt(0)
    v_readfirstlane_b32 s54, v1
    s_nop 0
    s_cmp_lt_u32 s54, 8
    s_cbranch_scc1 Lw_41
Lwx_42:
    s_waitcnt lgkmcnt(0)
    buffer_load_dwordx4 v[32:35], v2, s[44:47], 0 offen offset:0 nt
    s_mov_b32 s54, 8192
    buffer_load_dwordx4 v[36:39], v2, s[44:47], s54 offen offset:0 nt
    s_mov_b32 s54, 16384
    buffer_load_dwordx4 v[40:43], v2, s[44:47], s54 offen offset:0 nt
    s_mov_b32 s54, 24576
    buffer_load_dwordx4 v[44:47], v2, s[44:47], s54 offen offset:0 nt
    s_mov_b32 s54, 32768
    buffer_load_dwordx4 v[48:51], v2, s[44:47], s54 offen offset:0 nt
    s_mov_b32 s54, 40960
    buffer_load_dwordx4 v[52:55], v2, s[44:47], s54 offen offset:0 nt
    s_mov_b32 s54, 49152
    buffer_load_dwordx4 v[56:59], v2, s[44:47], s54 offen offset:0 nt
    s_mov_b32 s54, 57344
    buffer_load_dwordx4 v[60:63], v2, s[44:47], s54 offen offset:0 nt
    v_mov_b32 v160, v21
    v_mov_b32 v144, 0
    v_mov_b32 v145, 0
    v_mov_b32 v146, 0
    v_mov_b32 v147, 0
    v_mov_b32 v148, 0
    v_mov_b32 v149, 0
    v_mov_b32 v150, 0
    v_mov_b32 v151, 0
    v_mov_b32 v152, 0
    v_mov_b32 v153, 0
    v_mov_b32 v154, 0
    v_mov_b32 v155, 0
    v_mov_b32 v156, 0
    v_mov_b32 v157, 0
    v_mov_b32 v158, 0
    v_mov_b32 v159, 0
    s_mov_b32 s39, 320000
Lw_43:
    ds_read_b32 v1, v167 offset:16
    s_sub_u32 s39, s39, 1
    s_cbranch_scc1 Lwx_44
    s_sleep 1
    s_waitcnt lgkmcnt(0)
    v_readfirstlane_b32 s54, v1
    s_nop 0
    s_cmp_lt_u32 s54, 8
    s_cbranch_scc1 Lw_43
Lwx_44:
    s_waitcnt lgkmcnt(0)
    v_mov_b32 v31, 0xff
    s_mov_b32 s39, 40000
    s_mov_b64 s[58:59], -1
    s_mov_b64 s[60:61], -1
    s_mov_b64 s[62:63], -1
    buffer_load_dwordx3 v[8:10], v5, s[40:43], 0 offen sc1
    buffer_load_dwordx3 v[12:14], v5, s[40:43], 0 offen offset:16 sc1
    buffer_load_dwordx4 v[64:67], v4, s[40:43], 0 offen offset:0 sc1
    buffer_load_dwordx4 v[68:71], v4, s[40:43], 0 offen offset:256 sc1
    buffer_load_dwordx4 v[72:75], v4, s[40:43], 0 offen offset:2048 sc1
    buffer_load_dwordx4 v[76:79], v4, s[40:43], 0 offen offset:2304 sc1
    s_waitcnt vmcnt(12)
    v_perm_b32 v96, v36, v32, s52
    v_perm_b32 v100, v36, v32, s53
    v_perm_b32 v104, v37, v33, s52
    v_perm_b32 v108, v37, v33, s53
    v_perm_b32 v112, v38, v34, s52
    v_perm_b32 v116, v38, v34, s53
    v_perm_b32 v120, v39, v35, s52
    v_perm_b32 v124, v39, v35, s53
    s_waitcnt vmcnt(10)
    v_perm_b32 v97, v44, v40, s52
    v_perm_b32 v101, v44, v40, s53
    v_perm_b32 v105, v45, v41, s52
    v_perm_b32 v109, v45, v41, s53
    v_perm_b32 v113, v46, v42, s52
    v_perm_b32 v117, v46, v42, s53
    v_perm_b32 v121, v47, v43, s52
    v_perm_b32 v125, v47, v43, s53
    s_waitcnt vmcnt(8)
    v_perm_b32 v98, v52, v48, s52
    v_perm_b32 v102, v52, v48, s53
    v_perm_b32 v106, v53, v49, s52
    v_perm_b32 v110, v53, v49, s53
    v_perm_b32 v114, v54, v50, s52
    v_perm_b32 v118, v54, v50, s53
    v_perm_b32 v122, v55, v51, s52
    v_perm_b32 v126, v55, v51, s53
    s_waitcnt vmcnt(6)
    v_perm_b32 v99, v60, v56, s52
    v_perm_b32 v103, v60, v56, s53
    v_perm_b32 v107, v61, v57, s52
    v_perm_b32 v111, v61, v57, s53
    v_perm_b32 v115, v62, v58, s52
    v_perm_b32 v119, v62, v58, s53
    v_perm_b32 v123, v63, v59, s52
    v_perm_b32 v127, v63, v59, s53
    s_branch Lpsc_47
Lps_45:
    s_mov_b64 exec, s[58:59]
    buffer_load_dwordx3 v[8:10], v5, s[40:43], 0 offen sc1
    buffer_load_dwordx3 v[12:14], v5, s[40:43], 0 offen offset:16 sc1
    s_mov_b64 exec, s[60:61]
    buffer_load_dwordx4 v[64:67], v4, s[40:43], 0 offen offset:0 sc1
    buffer_load_dwordx4 v[68:71], v4, s[40:43], 0 offen offset:256 sc1
    s_mov_b64 exec, s[62:63]
    buffer_load_dwordx4 v[72:75], v4, s[40:43], 0 offen offset:2048 sc1
    buffer_load_dwordx4 v[76:79], v4, s[40:43], 0 offen offset:2304 sc1
    s_mov_b64 exec, -1
    s_sub_u32 s39, s39, 1
    s_cbranch_scc1 Lpsx_46
Lpsc_47:
    s_waitcnt vmcnt(4)
    s_nop 0
    v_xor_b32 v16, s37, v10
    v_xor_b32 v17, s37, v14
    v_or_b32 v16, v16, v17
    v_cmp_ne_u32 s[58:59], 0, v16
    s_waitcnt vmcnt(2)
    v_xor_b32 v128, s6, v64
    v_xor_b32 v129, s7, v65
    v_xor_b32 v130, s8, v66
    v_xor_b32 v131, s9, v67
    v_xor_b32 v132, s6, v68
    v_xor_b32 v133, s7, v69
    v_xor_b32 v134, s8, v70
    v_xor_b32 v135, s9, v71
    v_or3_b32 v16, v128, v129, v130
    v_or3_b32 v16, v16, v131, v132
    v_or3_b32 v16, v16, v133, v134
    v_or_b32 v16, v16, v135
    v_cmp_ne_u32_sdwa s[60:61], v16, v167 src0_sel:BYTE_0 src1_sel:DWORD
    s_waitcnt vmcnt(0)
    v_xor_b32 v136, s6, v72
    v_xor_b32 v137, s7, v73
    v_xor_b32 v138, s8, v74
    v_xor_b32 v139, s9, v75
    v_xor_b32 v140, s6, v76
    v_xor_b32 v141, s7, v77
    v_xor_b32 v142, s8, v78
    v_xor_b32 v143, s9, v79
    v_or3_b32 v16, v136, v137, v138
    v_or3_b32 v16, v16, v139, v140
    v_or3_b32 v16, v16, v141, v142
    v_or_b32 v16, v16, v143
    v_cmp_ne_u32_sdwa s[62:63], v16, v167 src0_sel:BYTE_0 src1_sel:DWORD
    s_or_b64 vcc, s[58:59], s[60:61]
    s_or_b64 vcc, vcc, s[62:63]
    s_cbranch_scc1 Lps_45
Lpsx_46:
    s_waitcnt vmcnt(0)
    v_max_f32 v16, v8, v12
    s_nop 1
    v_max_f32_dpp v16, v16, v16 row_ror:8 row_mask:0xf bank_mask:0xf
    s_nop 1
    v_max_f32_dpp v16, v16, v16 row_ror:4 row_mask:0xf bank_mask:0xf
    v_sub_f32 v8, v8, v16
    v_sub_f32 v10, v12, v16
    v_exp_f32 v8, v8
    v_exp_f32 v10, v10
    v_mul_f32 v16, v8, v9
    v_fmac_f32 v16, v10, v13
    v_pk_mul_f32 v[128:129], v[128:129], v[8:9] op_sel_hi:[1,0]
    v_pk_mul_f32 v[130:131], v[130:131], v[8:9] op_sel_hi:[1,0]
    v_pk_mul_f32 v[132:133], v[132:133], v[8:9] op_sel_hi:[1,0]
    v_pk_mul_f32 v[134:135], v[134:135], v[8:9] op_sel_hi:[1,0]
    v_add_f32_dpp v16, v16, v16 row_ror:8 row_mask:0xf bank_mask:0xf
    v_pk_fma_f32 v[128:129], v[136:137], v[10:11], v[128:129] op_sel_hi:[1,0,1]
    v_pk_fma_f32 v[130:131], v[138:139], v[10:11], v[130:131] op_sel_hi:[1,0,1]
    v_pk_fma_f32 v[132:133], v[140:141], v[10:11], v[132:133] op_sel_hi:[1,0,1]
    v_pk_fma_f32 v[134:135], v[142:143], v[10:11], v[134:135] op_sel_hi:[1,0,1]
    v_add_f32_dpp v16, v16, v16 row_ror:4 row_mask:0xf bank_mask:0xf
    v_add_f32_dpp v128, v128, v128 row_ror:8 row_mask:0xf bank_mask:0xf
    v_add_f32_dpp v129, v129, v129 row_ror:8 row_mask:0xf bank_mask:0xf
    v_add_f32_dpp v130, v130, v130 row_ror:8 row_mask:0xf bank_mask:0xf
    v_add_f32_dpp v131, v131, v131 row_ror:8 row_mask:0xf bank_mask:0xf
    v_add_f32_dpp v132, v132, v132 row_ror:8 row_mask:0xf bank_mask:0xf
    v_add_f32_dpp v133, v133, v133 row_ror:8 row_mask:0xf bank_mask:0xf
    v_add_f32_dpp v134, v134, v134 row_ror:8 row_mask:0xf bank_mask:0xf
    v_add_f32_dpp v135, v135, v135 row_ror:8 row_mask:0xf bank_mask:0xf
    v_rcp_f32 v16, v16
    v_add_f32_dpp v128, v128, v128 row_ror:4 row_mask:0xf bank_mask:0xf
    v_add_f32_dpp v129, v129, v129 row_ror:4 row_mask:0xf bank_mask:0xf
    v_add_f32_dpp v130, v130, v130 row_ror:4 row_mask:0xf bank_mask:0xf
    v_add_f32_dpp v131, v131, v131 row_ror:4 row_mask:0xf bank_mask:0xf
    v_add_f32_dpp v132, v132, v132 row_ror:4 row_mask:0xf bank_mask:0xf
    v_add_f32_dpp v133, v133, v133 row_ror:4 row_mask:0xf bank_mask:0xf
    v_add_f32_dpp v134, v134, v134 row_ror:4 row_mask:0xf bank_mask:0xf
    v_add_f32_dpp v135, v135, v135 row_ror:4 row_mask:0xf bank_mask:0xf
    v_pk_mul_f32 v[128:129], v[128:129], v[16:17] op_sel_hi:[1,0]
    v_pk_mul_f32 v[130:131], v[130:131], v[16:17] op_sel_hi:[1,0]
    v_pk_mul_f32 v[132:133], v[132:133], v[16:17] op_sel_hi:[1,0]
    v_pk_mul_f32 v[134:135], v[134:135], v[16:17] op_sel_hi:[1,0]
    s_mov_b32 exec_lo, 983055
    s_mov_b32 exec_hi, 983055
    v_cvt_pk_bf16_f32 v144, v128, v129
    v_cvt_pk_bf16_f32 v145, v130, v131
    v_cvt_pk_bf16_f32 v146, v132, v133
    v_cvt_pk_bf16_f32 v147, v134, v135
    s_mov_b32 exec_lo, 15728880
    s_mov_b32 exec_hi, 15728880
    v_cvt_pk_bf16_f32 v148, v128, v129
    v_cvt_pk_bf16_f32 v149, v130, v131
    v_cvt_pk_bf16_f32 v150, v132, v133
    v_cvt_pk_bf16_f32 v151, v134, v135
    s_mov_b32 exec_lo, 251662080
    s_mov_b32 exec_hi, 251662080
    v_cvt_pk_bf16_f32 v152, v128, v129
    v_cvt_pk_bf16_f32 v153, v130, v131
    v_cvt_pk_bf16_f32 v154, v132, v133
    v_cvt_pk_bf16_f32 v155, v134, v135
    s_mov_b32 exec_lo, 4026593280
    s_mov_b32 exec_hi, 4026593280
    v_cvt_pk_bf16_f32 v156, v128, v129
    v_cvt_pk_bf16_f32 v157, v130, v131
    v_cvt_pk_bf16_f32 v158, v132, v133
    v_cvt_pk_bf16_f32 v159, v134, v135
    s_mov_b64 exec, -1
    v_mfma_f32_16x16x32_bf16 v[16:19], v[144:147], v[96:99], 0
    v_mfma_f32_16x16x32_bf16 v[20:23], v[144:147], v[112:115], 0
    v_mfma_f32_16x16x32_bf16 v[16:19], v[148:151], v[100:103], v[16:19]
    v_mfma_f32_16x16x32_bf16 v[20:23], v[148:151], v[116:119], v[20:23]
    v_mfma_f32_16x16x32_bf16 v[16:19], v[152:155], v[104:107], v[16:19]
    v_mfma_f32_16x16x32_bf16 v[20:23], v[152:155], v[120:123], v[20:23]
    v_mfma_f32_16x16x32_bf16 v[16:19], v[156:159], v[108:111], v[16:19]
    v_mfma_f32_16x16x32_bf16 v[20:23], v[156:159], v[124:127], v[20:23]
    s_nop 6
    ds_write_b128 v6, v[16:19] offset:0
    ds_write_b128 v6, v[20:23] offset:64
    s_mov_b32 s55, 65536
    s_mov_b32 s56, 131072
    s_mov_b32 s57, 196608
    s_cmp_ge_u32 s32, 2
    s_waitcnt lgkmcnt(0)
    s_barrier
    s_cbranch_scc1 L_Rs
    ds_read_b128 v[8:11], v7 offset:0
    ds_read_b128 v[12:15], v7 offset:2304
    ds_read_b128 v[16:19], v7 offset:4608
    ds_read_b128 v[20:23], v7 offset:6912
    s_waitcnt lgkmcnt(2)
    v_pk_add_f32 v[8:9], v[8:9], v[12:13]
    v_pk_add_f32 v[10:11], v[10:11], v[14:15]
    s_waitcnt lgkmcnt(0)
    v_pk_add_f32 v[16:17], v[16:17], v[20:21]
    v_pk_add_f32 v[18:19], v[18:19], v[22:23]
    v_pk_add_f32 v[8:9], v[8:9], v[16:17]
    v_pk_add_f32 v[10:11], v[10:11], v[18:19]
    v_bfi_b32 v8, v31, s6, v8
    v_bfi_b32 v9, v31, s7, v9
    v_bfi_b32 v10, v31, s8, v10
    v_bfi_b32 v11, v31, s9, v11
    buffer_store_dwordx4 v[8:11], v3, s[40:43], 0 offen sc1
    s_branch L_R
L_Rs:
    s_sleep 3
L_R:
    buffer_load_ushort v160, v160, s[48:51], 0 offen
    s_mov_b32 s39, 40000
Lpt_48:
    buffer_load_dwordx2 v[26:27], v30, s[40:43], 0 offen sc1
    buffer_load_dwordx2 v[28:29], v30, s[40:43], s10 offen sc1
    s_sub_u32 s39, s39, 1
    s_waitcnt vmcnt(0)
    s_cbranch_scc1 Lptx_49
Lptc_50:
    s_nop 1
    v_cmp_ne_u32 vcc, s37, v27
    v_cmp_ne_u32 s[12:13], s37, v29
    s_nop 0
    s_or_b64 vcc, vcc, s[12:13]
    s_cbranch_scc1 Lpt_48
Lptx_49:
    v_lshlrev_b32 v160, 16, v160
    s_nop 0
    v_add_f32_dpp v161, v26, v26 row_ror:8 row_mask:0xf bank_mask:0xf
    v_add_f32_dpp v162, v28, v28 row_ror:8 row_mask:0xf bank_mask:0xf
    v_cvt_pk_bf16_f32 v2, v161, v162
    v_lshlrev_b32 v161, 16, v2
    v_and_b32 v162, s72, v2
    s_mov_b32 s39, 40000
    s_mov_b64 s[58:59], -1
    s_mov_b64 s[60:61], -1
    s_mov_b64 s[62:63], -1
    s_mov_b64 s[64:65], -1
Lps_51:
    s_mov_b64 exec, s[58:59]
    buffer_load_dwordx4 v[32:35], v163, s[40:43], 0 offen sc1
    s_mov_b64 exec, s[60:61]
    buffer_load_dwordx4 v[36:39], v163, s[40:43], s55 offen sc1
    s_mov_b64 exec, s[62:63]
    buffer_load_dwordx4 v[40:43], v163, s[40:43], s56 offen sc1
    s_mov_b64 exec, s[64:65]
    buffer_load_dwordx4 v[44:47], v163, s[40:43], s57 offen sc1
    s_mov_b64 exec, -1
    s_sub_u32 s39, s39, 1
    s_cbranch_scc1 Lpsx_52
Lpsc_53:
    s_waitcnt vmcnt(3)
    s_nop 0
    v_xor_b32 v48, s6, v32
    v_xor_b32 v49, s7, v33
    v_xor_b32 v50, s8, v34
    v_xor_b32 v51, s9, v35
    v_or3_b32 v16, v48, v49, v50
    v_or_b32 v16, v16, v51
    v_cmp_ne_u32_sdwa s[58:59], v16, v167 src0_sel:BYTE_0 src1_sel:DWORD
    s_waitcnt vmcnt(2)
    v_xor_b32 v52, s6, v36
    v_xor_b32 v53, s7, v37
    v_xor_b32 v54, s8, v38
    v_xor_b32 v55, s9, v39
    v_or3_b32 v16, v52, v53, v54
    v_or_b32 v16, v16, v55
    v_cmp_ne_u32_sdwa s[60:61], v16, v167 src0_sel:BYTE_0 src1_sel:DWORD
    s_waitcnt vmcnt(1)
    v_xor_b32 v56, s6, v40
    v_xor_b32 v57, s7, v41
    v_xor_b32 v58, s8, v42
    v_xor_b32 v59, s9, v43
    v_or3_b32 v16, v56, v57, v58
    v_or_b32 v16, v16, v59
    v_cmp_ne_u32_sdwa s[62:63], v16, v167 src0_sel:BYTE_0 src1_sel:DWORD
    s_waitcnt vmcnt(0)
    v_xor_b32 v60, s6, v44
    v_xor_b32 v61, s7, v45
    v_xor_b32 v62, s8, v46
    v_xor_b32 v63, s9, v47
    v_or3_b32 v16, v60, v61, v62
    v_or_b32 v16, v16, v63
    v_cmp_ne_u32_sdwa s[64:65], v16, v167 src0_sel:BYTE_0 src1_sel:DWORD
    s_or_b64 vcc, s[58:59], s[60:61]
    s_or_b64 vcc, vcc, s[62:63]
    s_or_b64 vcc, vcc, s[64:65]
    s_cbranch_scc1 Lps_51
Lpsx_52:
    s_waitcnt vmcnt(0)
    v_pk_add_f32 v[48:49], v[48:49], v[52:53]
    v_pk_add_f32 v[50:51], v[50:51], v[54:55]
    v_pk_add_f32 v[56:57], v[56:57], v[60:61]
    v_pk_add_f32 v[58:59], v[58:59], v[62:63]
    v_pk_add_f32 v[8:9], v[48:49], v[56:57]
    v_pk_add_f32 v[10:11], v[50:51], v[58:59]
    s_nop 1
    v_permlane32_swap_b32 v8, v10
    v_permlane32_swap_b32 v9, v11
    v_add_f32 v8, v8, v10
    v_add_f32 v9, v9, v11
    s_nop 1
    v_permlane16_swap_b32 v8, v9
    v_add_f32 v8, v8, v9
    s_nop 1
    v_add_f32_dpp v8, v8, v8 row_ror:8 row_mask:0xf bank_mask:0xf
    v_fma_f32 v8, v8, v161, v160
    v_mov_b32 v160, v8
    s_nop 0
    v_mov_b32_dpp v9, v8 quad_perm:[1,1,3,3] row_mask:0xf bank_mask:0xf
    v_mov_b32 v11, s37
    v_cvt_pk_bf16_f32 v8, v8, v9
    v_mov_b32 v9, s37
    s_nop 0
    v_mov_b32_dpp v10, v8 quad_perm:[2,2,2,2] row_mask:0xf bank_mask:0xf
    s_mov_b64 exec, s[66:67]
    buffer_store_dwordx4 v[8:11], v164, s[40:43], 0 offen
    s_mov_b64 exec, s[68:69]
    buffer_store_dwordx4 v[8:11], v164, s[40:43], 0 offen sc1
    s_mov_b64 exec, -1
    s_lshr_b32 s54, s33, 1
    s_cmp_lg_u32 s54, s32
    s_cbranch_scc1 L_fin2
    s_mov_b32 s55, 131072
    s_mov_b32 s56, 262144
    s_mov_b32 s57, 393216
    v_mov_b32 v76, s6
    v_mov_b32 v77, s7
    v_mov_b32 v78, s8
    v_mov_b32 v79, s9
    s_and_b32 s100, s33, 1
    s_lshl_b32 s100, s100, 2
    s_lshl_b32 s100, 0x00010001, s100
    v_cvt_pk_bf16_f32 v160, v160, v160
    v_and_b32 v160, s72, v160
    s_mov_b32 s46, 4096
    s_mov_b32 s47, 0x20000
    s_mov_b64 s[44:45], s[26:27]
    s_mov_b32 s39, 40000
    s_mov_b64 s[58:59], -1
    s_mov_b64 s[60:61], -1
    s_mov_b64 s[62:63], -1
    s_mov_b32 s64, -1
    s_mov_b32 s65, 0
    s_sleep 28
Lps_54:
    s_mov_b64 exec, s[58:59]
    buffer_load_dwordx4 v[64:67], v166, s[40:43], 0 offen sc1
    s_mov_b64 exec, s[60:61]
    buffer_load_dwordx4 v[68:71], v166, s[40:43], s55 offen sc1
    s_mov_b64 exec, s[62:63]
    buffer_load_dwordx4 v[72:75], v166, s[40:43], s56 offen sc1
    s_mov_b64 exec, s[64:65]
    buffer_load_dwordx4 v[76:79], v166, s[40:43], s57 offen sc1
    s_mov_b64 exec, -1
    s_sub_u32 s39, s39, 1
    s_cbranch_scc1 Lpsx_55
Lpsc_56:
    s_waitcnt vmcnt(3)
    s_nop 0
    v_xor_b32 v48, s6, v64
    v_xor_b32 v49, s7, v65
    v_xor_b32 v50, s8, v66
    v_xor_b32 v51, s9, v67
    v_or3_b32 v16, v48, v49, v50
    v_or_b32 v16, v16, v51
    v_cmp_ne_u32_sdwa s[58:59], v16, v167 src0_sel:BYTE_0 src1_sel:DWORD
    s_waitcnt vmcnt(2)
    v_xor_b32 v52, s6, v68
    v_xor_b32 v53, s7, v69
    v_xor_b32 v54, s8, v70
    v_xor_b32 v55, s9, v71
    v_or3_b32 v16, v52, v53, v54
    v_or_b32 v16, v16, v55
    v_cmp_ne_u32_sdwa s[60:61], v16, v167 src0_sel:BYTE_0 src1_sel:DWORD
    s_waitcnt vmcnt(1)
    v_xor_b32 v56, s6, v72
    v_xor_b32 v57, s7, v73
    v_xor_b32 v58, s8, v74
    v_xor_b32 v59, s9, v75
    v_or3_b32 v16, v56, v57, v58
    v_or_b32 v16, v16, v59
    v_cmp_ne_u32_sdwa s[62:63], v16, v167 src0_sel:BYTE_0 src1_sel:DWORD
    s_waitcnt vmcnt(0)
    v_xor_b32 v60, s6, v76
    v_xor_b32 v61, s7, v77
    v_xor_b32 v62, s8, v78
    v_xor_b32 v63, s9, v79
    v_or3_b32 v16, v60, v61, v62
    v_or_b32 v16, v16, v63
    v_cmp_ne_u32_sdwa s[64:65], v16, v167 src0_sel:BYTE_0 src1_sel:DWORD
    s_or_b64 vcc, s[58:59], s[60:61]
    s_or_b64 vcc, vcc, s[62:63]
    s_or_b64 vcc, vcc, s[64:65]
    s_cbranch_scc1 Lps_54
Lpsx_55:
    s_waitcnt vmcnt(0)
    v_pk_add_f32 v[48:49], v[48:49], v[52:53]
    v_pk_add_f32 v[50:51], v[50:51], v[54:55]
    v_pk_add_f32 v[56:57], v[56:57], v[60:61]
    v_pk_add_f32 v[58:59], v[58:59], v[62:63]
    v_pk_add_f32 v[8:9], v[48:49], v[56:57]
    v_pk_add_f32 v[10:11], v[50:51], v[58:59]
    s_nop 1
    v_permlane32_swap_b32 v8, v10
    v_permlane32_swap_b32 v9, v11
    v_add_f32 v8, v8, v10
    v_add_f32 v9, v9, v11
    s_nop 1
    v_permlane16_swap_b32 v8, v9
    v_add_f32 v8, v8, v9
    s_nop 1
    v_add_f32_dpp v8, v8, v8 row_ror:8 row_mask:0xf bank_mask:0xf
    s_nop 1
    v_add_f32_dpp v8, v8, v8 row_ror:4 row_mask:0xf bank_mask:0xf
    v_fma_f32 v8, v8, v162, v160
    s_nop 1
    v_mov_b32_dpp v9, v8 quad_perm:[1,1,3,3] row_mask:0xf bank_mask:0xf
    v_cvt_pk_bf16_f32 v8, v8, v9
    s_nop 1
    v_mov_b32_dpp v9, v8 quad_perm:[2,2,2,2] row_mask:0xf bank_mask:0xf
    s_mov_b32 exec_lo, s100
    s_mov_b32 exec_hi, s100
    buffer_store_dwordx2 v[8:9], v165, s[44:47], 0 offen
    s_cmp_lg_u32 s2, 32
    s_cbranch_scc1 L_fin
    s_mov_b64 exec, 1
    s_add_u32 s54, s38, 1
    v_mov_b32 v1, 0
    v_mov_b32 v2, s54
    buffer_store_dword v2, v1, s[40:43], 0 offen sc1
L_fin:
L_fin2:
L_end:
    s_endpgm
L_sN0:
    s_lshr_b32 s54, s34, 1
    s_cmp_eq_u32 s54, 5
    s_cbranch_scc1 L_sG
    s_cmp_eq_u32 s54, 13
    s_cbranch_scc1 L_sG
    s_and_b32 s54, s2, 0xe7
    s_cmp_eq_u32 s54, 3
    s_cbranch_scc1 L_sG
L_sN:
    s_xor_b32 s55, s98, 262144
    s_xor_b32 s56, s98, 524288
    s_xor_b32 s57, s98, 786432
    s_mov_b32 s50, 134217728
    s_mov_b32 s51, 0x20000
    s_mov_b64 s[48:49], s[8:9]
    s_mov_b32 s42, 16777216
    s_mov_b32 s43, 0x20000
    s_mov_b64 s[40:41], s[30:31]
    s_mov_b32 s52, 0x05040100
    s_mov_b32 s53, 0x07060302
    s_mov_b32 s72, 0xffff0000
    v_mov_b32 v163, 0
    v_mov_b32 v161, 1
    s_load_dword s38, s[30:31], 0
    v_cmp_eq_u32 s[58:59], 1, v3
    v_cmp_eq_u32 s[60:61], 2, v3
    v_cmp_eq_u32 s[62:63], 3, v3
    v_lshlrev_b32 v7, 5, v1
    s_lshr_b32 s54, s36, 1
    s_and_b32 s99, s36, 1
    s_mov_b32 s100, 655360
    s_lshl_b32 s101, s33, 11
    s_add_u32 s100, s100, s101
    s_lshl_b32 s101, s54, 7
    s_add_u32 s100, s100, s101
    s_lshl_b32 s101, s35, 5
    s_add_u32 s100, s100, s101
    s_lshl4_add_u32 s100, s99, s100
    v_bfe_u32 v2, v0, 2, 2
    v_lshl_add_u32 v160, v2, 9, s100
    s_lshl_b32 s100, s3, 2
    v_bfe_u32 v2, v0, 2, 2
    v_lshl_add_u32 v164, v2, 5, s100
    s_mov_b32 s100, 16384
    s_mul_i32 s101, s3, 2080
    s_add_u32 s100, s100, s101
    v_lshl_add_u32 v165, v0, 2, s100
    s_mov_b32 s100, 16384
    s_lshl_b32 s101, s3, 8
    s_add_u32 s100, s100, s101
    v_and_b32 v2, 3, v0
    v_mul_u32_u24 v2, 4160, v2
    v_add_u32 v166, s100, v2
    v_lshrrev_b32 v2, 2, v0
    v_lshl_add_u32 v166, v2, 4, v166
    s_lshr_b32 s54, s3, 1
    s_and_b32 s99, s3, 1
    s_mov_b32 s100, 131072
    s_lshl_b32 s101, s33, 16
    s_add_u32 s100, s100, s101
    s_lshl_b32 s101, s36, 11
    s_add_u32 s100, s100, s101
    s_lshl_b32 s101, s54, 9
    s_add_u32 s100, s100, s101
    s_lshl_b32 s101, s99, 7
    s_add_u32 s100, s100, s101
    s_lshl4_add_u32 s100, s35, s100
    v_lshrrev_b32 v2, 4, v0
    v_lshl_add_u32 v167, v2, 14, s100
    v_bfe_u32 v2, v0, 2, 1
    v_lshl_add_u32 v167, v2, 8, v167
    v_bfe_u32 v2, v0, 3, 1
    v_lshl_add_u32 v167, v2, 6, v167
    s_waitcnt vmcnt(2)
    buffer_load_dwordx4 v[44:47], v4, s[44:47], s98 offen offset:3072 nt
    s_waitcnt vmcnt(2)
    buffer_load_dwordx4 v[48:51], v4, s[44:47], s55 offen offset:0 nt
    s_waitcnt vmcnt(2)
    buffer_load_dwordx4 v[52:55], v4, s[44:47], s55 offen offset:1024 nt
    s_waitcnt vmcnt(2)
    buffer_load_dwordx4 v[56:59], v4, s[44:47], s55 offen offset:2048 nt
    s_waitcnt vmcnt(2)
    buffer_load_dwordx4 v[60:63], v4, s[44:47], s55 offen offset:3072 nt
    s_waitcnt vmcnt(2)
    buffer_load_dwordx4 v[64:67], v4, s[44:47], s56 offen offset:0 nt
    s_waitcnt vmcnt(2)
    buffer_load_dwordx4 v[68:71], v4, s[44:47], s56 offen offset:1024 nt
    s_waitcnt vmcnt(2)
    buffer_load_dwordx4 v[72:75], v4, s[44:47], s56 offen offset:2048 nt
    s_waitcnt vmcnt(2)
    buffer_load_dwordx4 v[76:79], v4, s[44:47], s56 offen offset:3072 nt
    s_waitcnt vmcnt(2)
    buffer_load_dwordx4 v[80:83], v4, s[44:47], s57 offen offset:0 nt
    s_waitcnt vmcnt(2)
    buffer_load_dwordx4 v[84:87], v4, s[44:47], s57 offen offset:1024 nt
    s_waitcnt vmcnt(2)
    buffer_load_dwordx4 v[88:91], v4, s[44:47], s57 offen offset:2048 nt
    s_waitcnt vmcnt(2)
    buffer_load_dwordx4 v[92:95], v4, s[44:47], s57 offen offset:3072 nt
    s_waitcnt vmcnt(2)
    buffer_load_dwordx4 v[96:99], v5, s[48:51], s98 offen offset:0 nt
    s_waitcnt vmcnt(2)
    buffer_load_dwordx4 v[100:103], v5, s[48:51], s98 offen offset:1024 nt
    ds_read_b32 v162, v163 offset:8
    s_waitcnt vmcnt(2)
    buffer_load_dwordx4 v[104:107], v5, s[48:51], s98 offen offset:2048 nt
    s_waitcnt lgkmcnt(0)
    v_readfirstlane_b32 s54, v162
    s_nop 0
    s_cmp_ge_u32 s54, 4
    s_cbranch_scc1 L_qk18
    ds_read_b32 v162, v163 offset:8
    s_waitcnt vmcnt(2)
    buffer_load_dwordx4 v[108:111], v5, s[48:51], s98 offen offset:3072 nt
    s_waitcnt lgkmcnt(0)
    v_readfirstlane_b32 s54, v162
    s_nop 0
    s_cmp_ge_u32 s54, 4
    s_cbranch_scc1 L_qk19
    ds_read_b32 v162, v163 offset:8
    s_waitcnt vmcnt(2)
    buffer_load_dwordx4 v[112:115], v5, s[48:51], s55 offen offset:0 nt
    s_waitcnt lgkmcnt(0)
    v_readfirstlane_b32 s54, v162
    s_nop 0
    s_cmp_ge_u32 s54, 4
    s_cbranch_scc1 L_qk20
    ds_read_b32 v162, v163 offset:8
    s_waitcnt vmcnt(2)
    buffer_load_dwordx4 v[116:119], v5, s[48:51], s55 offen offset:1024 nt
    s_mov_b64 exec, 1
    ds_add_u32 v163, v161 offset:20
    s_mov_b64 exec, -1
    s_waitcnt lgkmcnt(0)
    v_readfirstlane_b32 s54, v162
    s_nop 0
    s_cmp_ge_u32 s54, 4
    s_cbranch_scc1 L_qk21
    ds_read_b32 v162, v163 offset:8
    s_waitcnt vmcnt(2)
    buffer_load_dwordx4 v[120:123], v5, s[48:51], s55 offen offset:2048 nt
    s_waitcnt lgkmcnt(0)
    v_readfirstlane_b32 s54, v162
    s_nop 0
    s_cmp_ge_u32 s54, 4
    s_cbranch_scc1 L_qk22
    ds_read_b32 v162, v163 offset:8
    s_waitcnt vmcnt(2)
    buffer_load_dwordx4 v[124:127], v5, s[48:51], s55 offen offset:3072 nt
    s_waitcnt lgkmcnt(0)
    v_readfirstlane_b32 s54, v162
    s_nop 0
    s_cmp_ge_u32 s54, 4
    s_cbranch_scc1 L_qk23
    ds_read_b32 v162, v163 offset:8
    s_waitcnt vmcnt(3)
    buffer_load_dwordx4 v[128:131], v5, s[48:51], s56 offen offset:0 nt
    s_waitcnt lgkmcnt(0)
    v_readfirstlane_b32 s54, v162
    s_nop 0
    s_cmp_ge_u32 s54, 4
    s_cbranch_scc1 L_qk24
    ds_read_b32 v162, v163 offset:8
    s_waitcnt vmcnt(3)
    buffer_load_dwordx4 v[132:135], v5, s[48:51], s56 offen offset:1024 nt
    s_waitcnt lgkmcnt(0)
    v_readfirstlane_b32 s54, v162
    s_nop 0
    s_cmp_ge_u32 s54, 4
    s_cbranch_scc1 L_qk25
    ds_read_b32 v162, v163 offset:8
    s_waitcnt vmcnt(3)
    buffer_load_dwordx4 v[136:139], v5, s[48:51], s56 offen offset:2048 nt
    s_waitcnt lgkmcnt(0)
    v_readfirstlane_b32 s54, v162
    s_nop 0
    s_cmp_ge_u32 s54, 4
    s_cbranch_scc1 L_qk26
    ds_read_b32 v162, v163 offset:8
    s_waitcnt vmcnt(3)
    buffer_load_dwordx4 v[140:143], v5, s[48:51], s56 offen offset:3072 nt
    s_waitcnt lgkmcnt(0)
    v_readfirstlane_b32 s54, v162
    s_nop 0
    s_cmp_ge_u32 s54, 4
    s_cbranch_scc1 L_qk27
    ds_read_b32 v162, v163 offset:8
    s_waitcnt vmcnt(3)
    buffer_load_dwordx4 v[144:147], v5, s[48:51], s57 offen offset:0 nt
    s_waitcnt lgkmcnt(0)
    v_readfirstlane_b32 s54, v162
    s_nop 0
    s_cmp_ge_u32 s54, 4
    s_cbranch_scc1 L_qk28
    ds_read_b32 v162, v163 offset:8
    s_waitcnt vmcnt(3)
    buffer_load_dwordx4 v[148:151], v5, s[48:51], s57 offen offset:1024 nt
    s_waitcnt lgkmcnt(0)
    v_readfirstlane_b32 s54, v162
    s_nop 0
    s_cmp_ge_u32 s54, 4
    s_cbranch_scc1 L_qk29
    ds_read_b32 v162, v163 offset:8
    s_waitcnt vmcnt(3)
    buffer_load_dwordx4 v[152:155], v5, s[48:51], s57 offen offset:2048 nt
    s_waitcnt lgkmcnt(0)
    v_readfirstlane_b32 s54, v162
    s_nop 0
    s_cmp_ge_u32 s54, 4
    s_cbranch_scc1 L_qk30
    s_waitcnt vmcnt(3)
    buffer_load_dwordx4 v[156:159], v5, s[48:51], s57 offen offset:3072 nt
    s_mov_b64 exec, 1
    ds_add_u32 v163, v161 offset:12
    s_mov_b64 exec, -1
    s_mov_b32 s99, 32
    s_mov_b32 s39, 320000
Lw_57:
    ds_read_b32 v162, v163 offset:8
    s_sub_u32 s39, s39, 1
    s_cbranch_scc1 Lwx_58
    s_waitcnt lgkmcnt(0)
    v_readfirstlane_b32 s54, v162
    s_nop 0
    s_cmp_lt_u32 s54, 4
    s_cbranch_scc1 Lw_57
Lwx_58:
    s_waitcnt lgkmcnt(0)
L_QK:
    ds_read_b128 v[0:3], v6 offset:256
    ds_read_b32 v162, v163 offset:128
    s_waitcnt lgkmcnt(0)
    v_readfirstlane_b32 s73, v162
    v_mfma_f32_16x16x32_bf16 v[8:11], v[32:35], v[0:3], 0
    v_mfma_f32_16x16x32_bf16 v[12:15], v[36:39], v[0:3], 0
    v_mfma_f32_16x16x32_bf16 v[16:19], v[40:43], v[0:3], 0
    v_mfma_f32_16x16x32_bf16 v[20:23], v[44:47], v[0:3], 0
    v_mfma_f32_16x16x32_bf16 v[32:35], v[48:51], v[0:3], 0
    v_mfma_f32_16x16x32_bf16 v[36:39], v[52:55], v[0:3], 0
    v_mfma_f32_16x16x32_bf16 v[40:43], v[56:59], v[0:3], 0
    v_mfma_f32_16x16x32_bf16 v[44:47], v[60:63], v[0:3], 0
    v_mfma_f32_16x16x32_bf16 v[48:51], v[64:67], v[0:3], 0
    v_mfma_f32_16x16x32_bf16 v[52:55], v[68:71], v[0:3], 0
    v_mfma_f32_16x16x32_bf16 v[56:59], v[72:75], v[0:3], 0
    v_mfma_f32_16x16x32_bf16 v[60:63], v[76:79], v[0:3], 0
    v_mfma_f32_16x16x32_bf16 v[64:67], v[80:83], v[0:3], 0
    v_mfma_f32_16x16x32_bf16 v[68:71], v[84:87], v[0:3], 0
    v_mfma_f32_16x16x32_bf16 v[72:75], v[88:91], v[0:3], 0
    v_mfma_f32_16x16x32_bf16 v[76:79], v[92:95], v[0:3], 0
    s_cmp_lg_u32 s73, 0
    s_cselect_b32 s64, 0x11111111, 0
    s_cselect_b32 s65, 0x11111111, 0
    s_cselect_b32 s66, 0, 0x11111111
    s_cselect_b32 s67, 0, 0x11111111
    s_lshl_b32 s37, s38, 1
    s_add_u32 s37, s37, 0x9E3779B8
    s_mul_i32 s9, s38, 0x01010101
    s_add_u32 s9, s9, 0x5B3C1E87
    s_and_b32 s6, s9, 0xff
    s_bfe_u32 s7, s9, 0x80008
    s_bfe_u32 s8, s9, 0x80010
    s_lshr_b32 s9, s9, 24
    v_cndmask_b32 v24, v8, v13, s[58:59]
    v_cndmask_b32 v24, v24, v18, s[60:61]
    v_cndmask_b32 v24, v24, v23, s[62:63]
    v_cndmask_b32 v28, v12, v9, s[58:59]
    v_cndmask_b32 v28, v28, v22, s[60:61]
    v_cndmask_b32 v28, v28, v19, s[62:63]
    v_cndmask_b32 v29, v16, v21, s[58:59]
    v_cndmask_b32 v29, v29, v10, s[60:61]
    v_cndmask_b32 v29, v29, v15, s[62:63]
    v_cndmask_b32 v30, v20, v17, s[58:59]
    v_cndmask_b32 v30, v30, v14, s[60:61]
    v_cndmask_b32 v30, v30, v11, s[62:63]
    v_add_f32_dpp v24, v28, v24 quad_perm:[1,0,3,2] row_mask:0xf bank_mask:0xf
    s_nop 1
    v_add_f32_dpp v24, v29, v24 quad_perm:[2,3,0,1] row_mask:0xf bank_mask:0xf
    s_nop 1
    v_add_f32_dpp v24, v30, v24 quad_perm:[3,2,1,0] row_mask:0xf bank_mask:0xf
    v_cndmask_b32 v25, v32, v37, s[58:59]
    v_cndmask_b32 v25, v25, v42, s[60:61]
    v_cndmask_b32 v25, v25, v47, s[62:63]
    v_cndmask_b32 v28, v36, v33, s[58:59]
    v_cndmask_b32 v28, v28, v46, s[60:61]
    v_cndmask_b32 v28, v28, v43, s[62:63]
    v_cndmask_b32 v29, v40, v45, s[58:59]
    v_cndmask_b32 v29, v29, v34, s[60:61]
    v_cndmask_b32 v29, v29, v39, s[62:63]
    v_cndmask_b32 v30, v44, v41, s[58:59]
    v_cndmask_b32 v30, v30, v38, s[60:61]
    v_cndmask_b32 v30, v30, v35, s[62:63]
    v_add_f32_dpp v25, v28, v25 quad_perm:[1,0,3,2] row_mask:0xf bank_mask:0xf
    s_nop 1
    v_add_f32_dpp v25, v29, v25 quad_perm:[2,3,0,1] row_mask:0xf bank_mask:0xf
    s_nop 1
    v_add_f32_dpp v25, v30, v25 quad_perm:[3,2,1,0] row_mask:0xf bank_mask:0xf
    v_cndmask_b32 v26, v48, v53, s[58:59]
    v_cndmask_b32 v26, v26, v58, s[60:61]
    v_cndmask_b32 v26, v26, v63, s[62:63]
    v_cndmask_b32 v28, v52, v49, s[58:59]
    v_cndmask_b32 v28, v28, v62, s[60:61]
    v_cndmask_b32 v28, v28, v59, s[62:63]
    v_cndmask_b32 v29, v56, v61, s[58:59]
    v_cndmask_b32 v29, v29, v50, s[60:61]
    v_cndmask_b32 v29, v29, v55, s[62:63]
    v_cndmask_b32 v30, v60, v57, s[58:59]
    v_cndmask_b32 v30, v30, v54, s[60:61]
    v_cndmask_b32 v30, v30, v51, s[62:63]
    v_add_f32_dpp v26, v28, v26 quad_perm:[1,0,3,2] row_mask:0xf bank_mask:0xf
    s_nop 1
    v_add_f32_dpp v26, v29, v26 quad_perm:[2,3,0,1] row_mask:0xf bank_mask:0xf
    s_nop 1
    v_add_f32_dpp v26, v30, v26 quad_perm:[3,2,1,0] row_mask:0xf bank_mask:0xf
    v_cndmask_b32 v27, v64, v69, s[58:59]
    v_cndmask_b32 v27, v27, v74, s[60:61]
    v_cndmask_b32 v27, v27, v79, s[62:63]
    v_cndmask_b32 v28, v68, v65, s[58:59]
    v_cndmask_b32 v28, v28, v78, s[60:61]
    v_cndmask_b32 v28, v28, v75, s[62:63]
    v_cndmask_b32 v29, v72, v77, s[58:59]
    v_cndmask_b32 v29, v29, v66, s[60:61]
    v_cndmask_b32 v29, v29, v71, s[62:63]
    v_cndmask_b32 v30, v76, v73, s[58:59]
    v_cndmask_b32 v30, v30, v70, s[60:61]
    v_cndmask_b32 v30, v30, v67, s[62:63]
    v_add_f32_dpp v27, v28, v27 quad_perm:[1,0,3,2] row_mask:0xf bank_mask:0xf
    s_nop 1
    v_add_f32_dpp v27, v29, v27 quad_perm:[2,3,0,1] row_mask:0xf bank_mask:0xf
    s_nop 1
    v_add_f32_dpp v27, v30, v27 quad_perm:[3,2,1,0] row_mask:0xf bank_mask:0xf
    v_cvt_pk_bf16_f32 v28, v24, v25
    v_lshlrev_b32 v24, 16, v28
    v_and_b32 v25, s72, v28
    v_cvt_pk_bf16_f32 v29, v26, v27
    v_lshlrev_b32 v26, 16, v29
    v_and_b32 v27, s72, v29
    s_mov_b32 s54, 1035273459
    v_mul_f32 v24, s54, v24
    v_mul_f32 v25, s54, v25
    v_mul_f32 v26, s54, v26
    v_mul_f32 v27, s54, v27
    v_cvt_pk_bf16_f32 v28, v24, v25
    v_lshlrev_b32 v24, 16, v28
    v_and_b32 v25, s72, v28
    v_cvt_pk_bf16_f32 v29, v26, v27
    v_lshlrev_b32 v26, 16, v29
    v_and_b32 v27, s72, v29
    v_max3_f32 v28, v24, v25, v26
    v_max_f32 v28, v28, v27
    s_nop 1
    v_max_f32_dpp v28, v28, v28 quad_perm:[1,0,3,2] row_mask:0xf bank_mask:0xf
    s_nop 1
    v_max_f32_dpp v28, v28, v28 quad_perm:[2,3,0,1] row_mask:0xf bank_mask:0xf
    v_mov_b32 v29, v28
    s_nop 1
    v_permlane16_swap_b32 v28, v29
    v_max_f32 v28, v28, v29
    v_mov_b32 v29, v28
    s_nop 1
    v_permlane32_swap_b32 v28, v29
    v_max_f32 v28, v28, v29
    v_min_u32 v28, -2, v28
    ds_write_b32 v164, v28 offset:1280
    s_cmp_eq_u32 s99, 32
    s_cbranch_scc1 L_B32
    s_cmp_eq_u32 s99, 31
    s_cbranch_scc1 L_B31
    s_cmp_eq_u32 s99, 30
    s_cbranch_scc1 L_B30
    s_cmp_eq_u32 s99, 29
    s_cbranch_scc1 L_B29
    s_cmp_eq_u32 s99, 28
    s_cbranch_scc1 L_B28
    s_cmp_eq_u32 s99, 27
    s_cbranch_scc1 L_B27
    s_cmp_eq_u32 s99, 26
    s_cbranch_scc1 L_B26
    s_cmp_eq_u32 s99, 25
    s_cbranch_scc1 L_B25
    s_cmp_eq_u32 s99, 24
    s_cbranch_scc1 L_B24
    s_cmp_eq_u32 s99, 23
    s_cbranch_scc1 L_B23
    s_cmp_eq_u32 s99, 22
    s_cbranch_scc1 L_B22
    s_cmp_eq_u32 s99, 21
    s_cbranch_scc1 L_B21
L_B20:
    s_waitcnt vmcnt(2)
    buffer_load_dwordx4 v[112:115], v5, s[48:51], s55 offen offset:0 nt
L_B21:
    s_waitcnt vmcnt(2)
    buffer_load_dwordx4 v[116:119], v5, s[48:51], s55 offen offset:1024 nt
    s_mov_b64 exec, 1
    ds_add_u32 v163, v161 offset:20
    s_mov_b64 exec, -1
L_B22:
    s_waitcnt vmcnt(2)
    buffer_load_dwordx4 v[120:123], v5, s[48:51], s55 offen offset:2048 nt
L_B23:
    s_waitcnt vmcnt(2)
    buffer_load_dwordx4 v[124:127], v5, s[48:51], s55 offen offset:3072 nt
L_B24:
    s_waitcnt vmcnt(3)
    buffer_load_dwordx4 v[128:131], v5, s[48:51], s56 offen offset:0 nt
L_B25:
    s_waitcnt vmcnt(3)
    buffer_load_dwordx4 v[132:135], v5, s[48:51], s56 offen offset:1024 nt
L_B26:
    s_waitcnt vmcnt(3)
    buffer_load_dwordx4 v[136:139], v5, s[48:51], s56 offen offset:2048 nt
L_B27:
    s_waitcnt vmcnt(3)
    buffer_load_dwordx4 v[140:143], v5, s[48:51], s56 offen offset:3072 nt
L_B28:
    s_waitcnt vmcnt(3)
    buffer_load_dwordx4 v[144:147], v5, s[48:51], s57 offen offset:0 nt
L_B29:
    s_waitcnt vmcnt(3)
    buffer_load_dwordx4 v[148:151], v5, s[48:51], s57 offen offset:1024 nt
L_B30:
    s_waitcnt vmcnt(3)
    buffer_load_dwordx4 v[152:155], v5, s[48:51], s57 offen offset:2048 nt
L_B31:
    s_waitcnt vmcnt(3)
    buffer_load_dwordx4 v[156:159], v5, s[48:51], s57 offen offset:3072 nt
    s_mov_b64 exec, 1
    ds_add_u32 v163, v161 offset:12
    s_mov_b64 exec, -1
L_B32:
    s_waitcnt vmcnt(8)
    s_nop 0
    v_perm_b32 v32, v100, v96, s52
    v_perm_b32 v36, v100, v96, s53
    v_perm_b32 v40, v101, v97, s52
    v_perm_b32 v44, v101, v97, s53
    v_perm_b32 v48, v102, v98, s52
    v_perm_b32 v52, v102, v98, s53
    v_perm_b32 v56, v103, v99, s52
    v_perm_b32 v60, v103, v99, s53
    v_perm_b32 v33, v108, v104, s52
    v_perm_b32 v37, v108, v104, s53
    v_perm_b32 v41, v109, v105, s52
    v_perm_b32 v45, v109, v105, s53
    v_perm_b32 v49, v110, v106, s52
    v_perm_b32 v53, v110, v106, s53
    v_perm_b32 v57, v111, v107, s52
    v_perm_b32 v61, v111, v107, s53
    v_perm_b32 v34, v116, v112, s52
    v_perm_b32 v38, v116, v112, s53
    v_perm_b32 v42, v117, v113, s52
    v_perm_b32 v46, v117, v113, s53
    v_perm_b32 v50, v118, v114, s52
    v_perm_b32 v54, v118, v114, s53
    v_perm_b32 v58, v119, v115, s52
    v_perm_b32 v62, v119, v115, s53
    v_perm_b32 v35, v124, v120, s52
    v_perm_b32 v39, v124, v120, s53
    v_perm_b32 v43, v125, v121, s52
    v_perm_b32 v47, v125, v121, s53
    v_perm_b32 v51, v126, v122, s52
    v_perm_b32 v55, v126, v122, s53
    v_perm_b32 v59, v127, v123, s52
    v_perm_b32 v63, v127, v123, s53
    s_mov_b32 s39, 320000
Lb3_59:
    ds_read_b128 v[8:11], v7 offset:1280
    ds_read_b128 v[12:15], v7 offset:1296
    s_sub_u32 s39, s39, 1
    s_cbranch_scc1 Lb3x_60
    s_waitcnt lgkmcnt(0)
    v_max3_u32 v16, v8, v9, v10
    v_max3_u32 v17, v11, v12, v13
    v_max3_u32 v16, v16, v14, v15
    v_max_u32 v16, v16, v17
    v_cmp_eq_u32 vcc, -1, v16
    s_cbranch_vccnz Lb3_59
Lb3x_60:
    s_mov_b32 s54, 1069066811
    s_waitcnt lgkmcnt(0)
    v_max3_f32 v8, v8, v9, v10
    v_max3_f32 v12, v11, v12, v13
    v_max3_f32 v8, v8, v14, v15
    v_max_f32 v8, v8, v12
    v_mul_f32 v162, s54, v8
    v_fma_f32 v24, v24, s54, -v162
    v_fma_f32 v25, v25, s54, -v162
    v_fma_f32 v26, v26, s54, -v162
    v_fma_f32 v27, v27, s54, -v162
    v_exp_f32 v24, v24
    v_exp_f32 v25, v25
    v_exp_f32 v26, v26
    v_exp_f32 v27, v27
    v_mov_b32_dpp v28, v24 quad_perm:[1,1,3,3] row_mask:0xf bank_mask:0xf
    v_mov_b32_dpp v29, v25 quad_perm:[1,1,3,3] row_mask:0xf bank_mask:0xf
    v_mov_b32_dpp v30, v26 quad_perm:[1,1,3,3] row_mask:0xf bank_mask:0xf
    v_mov_b32_dpp v31, v27 quad_perm:[1,1,3,3] row_mask:0xf bank_mask:0xf
    v_cvt_pk_bf16_f32 v8, v24, v28
    v_cvt_pk_bf16_f32 v10, v25, v29
    v_cvt_pk_bf16_f32 v12, v26, v30
    v_cvt_pk_bf16_f32 v14, v27, v31
    v_mov_b32_dpp v9, v8 quad_perm:[2,2,2,2] row_mask:0xf bank_mask:0xf
    v_mov_b32_dpp v11, v10 quad_perm:[2,2,2,2] row_mask:0xf bank_mask:0xf
    v_mov_b32_dpp v13, v12 quad_perm:[2,2,2,2] row_mask:0xf bank_mask:0xf
    v_mov_b32_dpp v15, v14 quad_perm:[2,2,2,2] row_mask:0xf bank_mask:0xf
    v_mfma_f32_16x16x32_bf16 v[96:99], v[8:11], v[32:35], 0
    v_mfma_f32_16x16x32_bf16 v[100:103], v[8:11], v[36:39], 0
    v_mfma_f32_16x16x32_bf16 v[104:107], v[8:11], v[40:43], 0
    v_mfma_f32_16x16x32_bf16 v[108:111], v[8:11], v[44:47], 0
    v_mfma_f32_16x16x32_bf16 v[112:115], v[8:11], v[48:51], 0
    v_mfma_f32_16x16x32_bf16 v[116:119], v[8:11], v[52:55], 0
    v_mfma_f32_16x16x32_bf16 v[120:123], v[8:11], v[56:59], 0
    v_mfma_f32_16x16x32_bf16 v[124:127], v[8:11], v[60:63], 0
    v_add_f32 v24, v24, v25
    v_add_f32 v26, v26, v27
    v_add_f32 v24, v24, v26
    s_nop 1
    v_add_f32_dpp v24, v24, v24 quad_perm:[1,0,3,2] row_mask:0xf bank_mask:0xf
    s_nop 1
    v_add_f32_dpp v24, v24, v24 quad_perm:[2,3,0,1] row_mask:0xf bank_mask:0xf
    v_mov_b32 v25, v24
    s_nop 1
    v_permlane16_swap_b32 v24, v25
    v_add_f32 v24, v24, v25
    v_mov_b32 v25, v24
    s_nop 1
    v_permlane32_swap_b32 v24, v25
    v_add_f32 v24, v24, v25
    v_min_u32 v24, -2, v24
    v_mov_b32 v31, 0xff
    v_mov_b32 v28, v162
    v_mov_b32 v30, s37
    s_cmp_eq_u32 s3, 7
    s_cselect_b32 s54, 0xffff, 0
    s_and_b32 s68, s64, s54
    s_mov_b32 s69, 0
    s_and_b32 s70, s66, s54
    s_mov_b32 s71, 0
    s_waitcnt vmcnt(4)
    v_perm_b32 v64, v132, v128, s52
    v_perm_b32 v68, v132, v128, s53
    v_perm_b32 v72, v133, v129, s52
    v_perm_b32 v76, v133, v129, s53
    v_perm_b32 v80, v134, v130, s52
    v_perm_b32 v84, v134, v130, s53
    v_perm_b32 v88, v135, v131, s52
    v_perm_b32 v92, v135, v131, s53
    v_perm_b32 v65, v140, v136, s52
    v_perm_b32 v69, v140, v136, s53
    v_perm_b32 v73, v141, v137, s52
    v_perm_b32 v77, v141, v137, s53
    v_perm_b32 v81, v142, v138, s52
    v_perm_b32 v85, v142, v138, s53
    v_perm_b32 v89, v143, v139, s52
    v_perm_b32 v93, v143, v139, s53
    s_waitcnt vmcnt(2)
    v_perm_b32 v66, v148, v144, s52
    v_perm_b32 v70, v148, v144, s53
    v_perm_b32 v74, v149, v145, s52
    v_perm_b32 v78, v149, v145, s53
    v_perm_b32 v82, v150, v146, s52
    v_perm_b32 v86, v150, v146, s53
    v_perm_b32 v90, v151, v147, s52
    v_perm_b32 v94, v151, v147, s53
    s_waitcnt vmcnt(0)
    v_perm_b32 v67, v156, v152, s52
    v_perm_b32 v71, v156, v152, s53
    v_perm_b32 v75, v157, v153, s52
    v_perm_b32 v79, v157, v153, s53
    v_perm_b32 v83, v158, v154, s52
    v_perm_b32 v87, v158, v154, s53
    v_perm_b32 v91, v159, v155, s52
    v_perm_b32 v95, v159, v155, s53
    v_mfma_f32_16x16x32_bf16 v[96:99], v[12:15], v[64:67], v[96:99]
    v_mfma_f32_16x16x32_bf16 v[100:103], v[12:15], v[68:71], v[100:103]
    v_mfma_f32_16x16x32_bf16 v[104:107], v[12:15], v[72:75], v[104:107]
    v_mfma_f32_16x16x32_bf16 v[108:111], v[12:15], v[76:79], v[108:111]
    v_mfma_f32_16x16x32_bf16 v[112:115], v[12:15], v[80:83], v[112:115]
    v_mfma_f32_16x16x32_bf16 v[116:119], v[12:15], v[84:87], v[116:119]
    v_mfma_f32_16x16x32_bf16 v[120:123], v[12:15], v[88:91], v[120:123]
    v_mfma_f32_16x16x32_bf16 v[124:127], v[12:15], v[92:95], v[124:127]
    s_nop 0
    ds_write_b32 v165, v96 offset:0
    ds_write_b32 v165, v100 offset:256
    ds_write_b32 v165, v104 offset:512
    ds_write_b32 v165, v108 offset:768
    ds_write_b32 v165, v112 offset:1024
    ds_write_b32 v165, v116 offset:1280
    ds_write_b32 v165, v120 offset:1536
    ds_write_b32 v165, v124 offset:1792
    ds_write_b32 v164, v24 offset:1408
    s_mov_b32 s39, 320000
Lb4_61:
    ds_read_b128 v[16:19], v7 offset:1408
    ds_read_b128 v[20:23], v7 offset:1424
    ds_read_b128 v[8:11], v166
    ds_read_b128 v[12:15], v166 offset:2080
    s_sub_u32 s39, s39, 1
    s_cbranch_scc1 Lb4x_62
    s_waitcnt lgkmcnt(2)
    v_max3_u32 v24, v16, v17, v18
    v_max3_u32 v25, v19, v20, v21
    v_max3_u32 v24, v24, v22, v23
    v_max_u32 v24, v24, v25
    v_cmp_eq_u32 vcc, -1, v24
    s_waitcnt lgkmcnt(0)
    s_cbranch_vccnz Lb4_61
Lb4x_62:
    s_waitcnt lgkmcnt(0)
    v_add_f32 v8, v8, v12
    v_add_f32 v9, v9, v13
    v_add_f32 v10, v10, v14
    v_add_f32 v11, v11, v15
    v_add_f32_dpp v8, v8, v8 quad_perm:[1,0,3,2] row_mask:0xf bank_mask:0xf
    v_add_f32_dpp v9, v9, v9 quad_perm:[1,0,3,2] row_mask:0xf bank_mask:0xf
    v_add_f32_dpp v10, v10, v10 quad_perm:[1,0,3,2] row_mask:0xf bank_mask:0xf
    v_add_f32_dpp v11, v11, v11 quad_perm:[1,0,3,2] row_mask:0xf bank_mask:0xf
    v_add_f32_dpp v8, v8, v8 quad_perm:[2,3,0,1] row_mask:0xf bank_mask:0xf
    v_add_f32_dpp v9, v9, v9 quad_perm:[2,3,0,1] row_mask:0xf bank_mask:0xf
    v_add_f32_dpp v10, v10, v10 quad_perm:[2,3,0,1] row_mask:0xf bank_mask:0xf
    v_add_f32_dpp v11, v11, v11 quad_perm:[2,3,0,1] row_mask:0xf bank_mask:0xf
    v_bfi_b32 v8, v31, s6, v8
    v_bfi_b32 v9, v31, s7, v9
    v_bfi_b32 v10, v31, s8, v10
    v_bfi_b32 v11, v31, s9, v11
    s_mov_b64 exec, s[64:65]
    buffer_store_dwordx4 v[8:11], v167, s[40:43], 0 offen
    s_mov_b64 exec, s[66:67]
    buffer_store_dwordx4 v[8:11], v167, s[40:43], 0 offen sc1
    s_mov_b64 exec, -1
    s_cmp_lg_u32 s3, 7
    s_cbranch_scc1 L_nost
    v_pk_add_f32 v[16:17], v[16:17], v[18:19]
    v_pk_add_f32 v[20:21], v[20:21], v[22:23]
    v_pk_add_f32 v[16:17], v[16:17], v[20:21]
    v_add_f32 v29, v16, v17
    s_mov_b64 exec, s[68:69]
    buffer_store_dwordx3 v[28:30], v160, s[40:43], 0 offen
    s_mov_b64 exec, s[70:71]
    buffer_store_dwordx3 v[28:30], v160, s[40:43], 0 offen sc1
    s_mov_b64 exec, -1
L_nost:
    s_mov_b64 exec, 1
    ds_add_u32 v163, v161 offset:16
    s_mov_b64 exec, -1
    s_mov_b64 exec, 1
    ds_add_u32 v163, v161 offset:28
    s_mov_b64 exec, -1
L_send:
    s_endpgm
L_qk18:
    buffer_load_dwordx4 v[108:111], v5, s[48:51], s98 offen offset:3072 nt
    s_mov_b32 s99, 20
    s_branch L_QK
L_qk19:
    buffer_load_dwordx4 v[112:115], v5, s[48:51], s55 offen offset:0 nt
    s_mov_b32 s99, 21
    s_branch L_QK
L_qk20:
    buffer_load_dwordx4 v[116:119], v5, s[48:51], s55 offen offset:1024 nt
    s_mov_b64 exec, 1
    ds_add_u32 v163, v161 offset:20
    s_mov_b64 exec, -1
    s_mov_b32 s99, 22
    s_branch L_QK
L_qk21:
    buffer_load_dwordx4 v[120:123], v5, s[48:51], s55 offen offset:2048 nt
    s_mov_b32 s99, 23
    s_branch L_QK
L_qk22:
    buffer_load_dwordx4 v[124:127], v5, s[48:51], s55 offen offset:3072 nt
    s_mov_b32 s99, 24
    s_branch L_QK
L_qk23:
    buffer_load_dwordx4 v[128:131], v5, s[48:51], s56 offen offset:0 nt
    s_mov_b32 s99, 25
    s_branch L_QK
L_qk24:
    buffer_load_dwordx4 v[132:135], v5, s[48:51], s56 offen offset:1024 nt
    s_mov_b32 s99, 26
    s_branch L_QK
L_qk25:
    buffer_load_dwordx4 v[136:139], v5, s[48:51], s56 offen offset:2048 nt
    s_mov_b32 s99, 27
    s_branch L_QK
L_qk26:
    buffer_load_dwordx4 v[140:143], v5, s[48:51], s56 offen offset:3072 nt
    s_mov_b32 s99, 28
    s_branch L_QK
L_qk27:
    buffer_load_dwordx4 v[144:147], v5, s[48:51], s57 offen offset:0 nt
    s_mov_b32 s99, 29
    s_branch L_QK
L_qk28:
    buffer_load_dwordx4 v[148:151], v5, s[48:51], s57 offen offset:1024 nt
    s_mov_b32 s99, 30
    s_branch L_QK
L_qk29:
    buffer_load_dwordx4 v[152:155], v5, s[48:51], s57 offen offset:2048 nt
    s_mov_b32 s99, 31
    s_branch L_QK
L_qk30:
    buffer_load_dwordx4 v[156:159], v5, s[48:51], s57 offen offset:3072 nt
    s_mov_b64 exec, 1
    ds_add_u32 v163, v161 offset:12
    s_mov_b64 exec, -1
    s_mov_b32 s99, 32
    s_branch L_QK
L_sG:
    buffer_load_dwordx4 v[44:47], v4, s[44:47], s98 offen offset:3072 nt
    s_xor_b32 s55, s98, 262144
    s_xor_b32 s56, s98, 524288
    s_xor_b32 s57, s98, 786432
    s_mov_b32 s50, 134217728
    s_mov_b32 s51, 0x20000
    s_mov_b64 s[48:49], s[8:9]
    s_mov_b32 s42, 16777216
    s_mov_b32 s43, 0x20000
    s_mov_b64 s[40:41], s[30:31]
    s_mov_b32 s52, 0x05040100
    s_mov_b32 s53, 0x07060302
    s_mov_b32 s72, 0xffff0000
    v_mov_b32 v163, 0
    v_mov_b32 v161, 1
    s_load_dword s38, s[30:31], 0
    v_cmp_eq_u32 s[58:59], 1, v3
    v_cmp_eq_u32 s[60:61], 2, v3
    v_cmp_eq_u32 s[62:63], 3, v3
    v_lshlrev_b32 v7, 5, v1
    s_lshr_b32 s54, s36, 1
    s_and_b32 s99, s36, 1
    s_mov_b32 s100, 655360
    s_lshl_b32 s101, s33, 11
    s_add_u32 s100, s100, s101
    s_lshl_b32 s101, s54, 7
    s_add_u32 s100, s100, s101
    s_lshl_b32 s101, s35, 5
    s_add_u32 s100, s100, s101
    s_lshl4_add_u32 s100, s99, s100
    v_bfe_u32 v2, v0, 2, 2
    v_lshl_add_u32 v160, v2, 9, s100
    s_lshl_b32 s100, s3, 2
    v_bfe_u32 v2, v0, 2, 2
    v_lshl_add_u32 v164, v2, 5, s100
    s_mov_b32 s100, 16384
    s_mul_i32 s101, s3, 2080
    s_add_u32 s100, s100, s101
    v_lshl_add_u32 v165, v0, 2, s100
    s_mov_b32 s100, 16384
    s_lshl_b32 s101, s3, 8
    s_add_u32 s100, s100, s101
    v_and_b32 v2, 3, v0
    v_mul_u32_u24 v2, 4160, v2
    v_add_u32 v166, s100, v2
    v_lshrrev_b32 v2, 2, v0
    v_lshl_add_u32 v166, v2, 4, v166
    s_lshr_b32 s54, s3, 1
    s_and_b32 s99, s3, 1
    s_mov_b32 s100, 131072
    s_lshl_b32 s101, s33, 16
    s_add_u32 s100, s100, s101
    s_lshl_b32 s101, s36, 11
    s_add_u32 s100, s100, s101
    s_lshl_b32 s101, s54, 9
    s_add_u32 s100, s100, s101
    s_lshl_b32 s101, s99, 7
    s_add_u32 s100, s100, s101
    s_lshl4_add_u32 s100, s35, s100
    v_lshrrev_b32 v2, 4, v0
    v_lshl_add_u32 v167, v2, 14, s100
    v_bfe_u32 v2, v0, 2, 1
    v_lshl_add_u32 v167, v2, 8, v167
    v_bfe_u32 v2, v0, 3, 1
    v_lshl_add_u32 v167, v2, 6, v167
    s_waitcnt vmcnt(3)
    buffer_load_dwordx4 v[48:51], v4, s[44:47], s55 offen offset:0 nt
    s_waitcnt vmcnt(3)
    buffer_load_dwordx4 v[52:55], v4, s[44:47], s55 offen offset:1024 nt
    s_waitcnt vmcnt(3)
    buffer_load_dwordx4 v[56:59], v4, s[44:47], s55 offen offset:2048 nt
    s_waitcnt vmcnt(3)
    buffer_load_dwordx4 v[60:63], v4, s[44:47], s55 offen offset:3072 nt
    s_waitcnt vmcnt(3)
    buffer_load_dwordx4 v[64:67], v4, s[44:47], s56 offen offset:0 nt
    s_waitcnt vmcnt(3)
    buffer_load_dwordx4 v[68:71], v4, s[44:47], s56 offen offset:1024 nt
    s_waitcnt vmcnt(3)
    buffer_load_dwordx4 v[72:75], v4, s[44:47], s56 offen offset:2048 nt
    s_waitcnt vmcnt(3)
    buffer_load_dwordx4 v[76:79], v4, s[44:47], s56 offen offset:3072 nt
    s_waitcnt vmcnt(3)
    buffer_load_dwordx4 v[80:83], v4, s[44:47], s57 offen offset:0 nt
    s_waitcnt vmcnt(3)
    buffer_load_dwordx4 v[84:87], v4, s[44:47], s57 offen offset:1024 nt
    s_waitcnt vmcnt(3)
    buffer_load_dwordx4 v[88:91], v4, s[44:47], s57 offen offset:2048 nt
    s_waitcnt vmcnt(3)
    buffer_load_dwordx4 v[92:95], v4, s[44:47], s57 offen offset:3072 nt
    s_waitcnt vmcnt(3)
    buffer_load_dwordx4 v[96:99], v5, s[48:51], s98 offen offset:0 nt
    s_waitcnt vmcnt(3)
    buffer_load_dwordx4 v[100:103], v5, s[48:51], s98 offen offset:1024 nt
    s_waitcnt vmcnt(3)
    buffer_load_dwordx4 v[104:107], v5, s[48:51], s98 offen offset:2048 nt
    ds_read_b32 v162, v163 offset:8
    s_waitcnt vmcnt(3)
    buffer_load_dwordx4 v[108:111], v5, s[48:51], s98 offen offset:3072 nt
    s_waitcnt lgkmcnt(0)
    v_readfirstlane_b32 s54, v162
    s_nop 0
    s_cmp_ge_u32 s54, 4
    s_cbranch_scc1 Lg_qk19
    ds_read_b32 v162, v163 offset:8
    s_waitcnt vmcnt(3)
    buffer_load_dwordx4 v[112:115], v5, s[48:51], s55 offen offset:0 nt
    s_waitcnt lgkmcnt(0)
    v_readfirstlane_b32 s54, v162
    s_nop 0
    s_cmp_ge_u32 s54, 4
    s_cbranch_scc1 Lg_qk20
    ds_read_b32 v162, v163 offset:8
    s_waitcnt vmcnt(3)
    buffer_load_dwordx4 v[116:119], v5, s[48:51], s55 offen offset:1024 nt
    s_mov_b64 exec, 1
    ds_add_u32 v163, v161 offset:20
    s_mov_b64 exec, -1
    s_waitcnt lgkmcnt(0)
    v_readfirstlane_b32 s54, v162
    s_nop 0
    s_cmp_ge_u32 s54, 4
    s_cbranch_scc1 Lg_qk21
    ds_read_b32 v162, v163 offset:8
    s_waitcnt vmcnt(3)
    buffer_load_dwordx4 v[120:123], v5, s[48:51], s55 offen offset:2048 nt
    s_waitcnt lgkmcnt(0)
    v_readfirstlane_b32 s54, v162
    s_nop 0
    s_cmp_ge_u32 s54, 4
    s_cbranch_scc1 Lg_qk22
    ds_read_b32 v162, v163 offset:8
    s_waitcnt vmcnt(3)
    buffer_load_dwordx4 v[124:127], v5, s[48:51], s55 offen offset:3072 nt
    s_waitcnt lgkmcnt(0)
    v_readfirstlane_b32 s54, v162
    s_nop 0
    s_cmp_ge_u32 s54, 4
    s_cbranch_scc1 Lg_qk23
    ds_read_b32 v162, v163 offset:8
    s_waitcnt vmcnt(3)
    buffer_load_dwordx4 v[128:131], v5, s[48:51], s56 offen offset:0 nt
    s_waitcnt lgkmcnt(0)
    v_readfirstlane_b32 s54, v162
    s_nop 0
    s_cmp_ge_u32 s54, 4
    s_cbranch_scc1 Lg_qk24
    ds_read_b32 v162, v163 offset:8
    s_waitcnt vmcnt(3)
    buffer_load_dwordx4 v[132:135], v5, s[48:51], s56 offen offset:1024 nt
    s_waitcnt lgkmcnt(0)
    v_readfirstlane_b32 s54, v162
    s_nop 0
    s_cmp_ge_u32 s54, 4
    s_cbranch_scc1 Lg_qk25
    ds_read_b32 v162, v163 offset:8
    s_waitcnt vmcnt(3)
    buffer_load_dwordx4 v[136:139], v5, s[48:51], s56 offen offset:2048 nt
    s_waitcnt lgkmcnt(0)
    v_readfirstlane_b32 s54, v162
    s_nop 0
    s_cmp_ge_u32 s54, 4
    s_cbranch_scc1 Lg_qk26
    ds_read_b32 v162, v163 offset:8
    s_waitcnt vmcnt(3)
    buffer_load_dwordx4 v[140:143], v5, s[48:51], s56 offen offset:3072 nt
    s_waitcnt lgkmcnt(0)
    v_readfirstlane_b32 s54, v162
    s_nop 0
    s_cmp_ge_u32 s54, 4
    s_cbranch_scc1 Lg_qk27
    ds_read_b32 v162, v163 offset:8
    s_waitcnt vmcnt(3)
    buffer_load_dwordx4 v[144:147], v5, s[48:51], s57 offen offset:0 nt
    s_waitcnt lgkmcnt(0)
    v_readfirstlane_b32 s54, v162
    s_nop 0
    s_cmp_ge_u32 s54, 4
    s_cbranch_scc1 Lg_qk28
    ds_read_b32 v162, v163 offset:8
    s_waitcnt vmcnt(3)
    buffer_load_dwordx4 v[148:151], v5, s[48:51], s57 offen offset:1024 nt
    s_waitcnt lgkmcnt(0)
    v_readfirstlane_b32 s54, v162
    s_nop 0
    s_cmp_ge_u32 s54, 4
    s_cbranch_scc1 Lg_qk29
    ds_read_b32 v162, v163 offset:8
    s_waitcnt vmcnt(3)
    buffer_load_dwordx4 v[152:155], v5, s[48:51], s57 offen offset:2048 nt
    s_waitcnt lgkmcnt(0)
    v_readfirstlane_b32 s54, v162
    s_nop 0
    s_cmp_ge_u32 s54, 4
    s_cbranch_scc1 Lg_qk30
    s_waitcnt vmcnt(3)
    buffer_load_dwordx4 v[156:159], v5, s[48:51], s57 offen offset:3072 nt
    s_mov_b64 exec, 1
    ds_add_u32 v163, v161 offset:12
    s_mov_b64 exec, -1
    s_mov_b32 s99, 32
    s_mov_b32 s39, 320000
Lw_63:
    ds_read_b32 v162, v163 offset:8
    s_sub_u32 s39, s39, 1
    s_cbranch_scc1 Lwx_64
    s_waitcnt lgkmcnt(0)
    v_readfirstlane_b32 s54, v162
    s_nop 0
    s_cmp_lt_u32 s54, 4
    s_cbranch_scc1 Lw_63
Lwx_64:
    s_waitcnt lgkmcnt(0)
Lg_QK:
    ds_read_b128 v[0:3], v6 offset:256
    ds_read_b32 v162, v163 offset:128
    s_waitcnt lgkmcnt(0)
    v_readfirstlane_b32 s73, v162
    v_mfma_f32_16x16x32_bf16 v[8:11], v[32:35], v[0:3], 0
    v_mfma_f32_16x16x32_bf16 v[12:15], v[36:39], v[0:3], 0
    v_mfma_f32_16x16x32_bf16 v[16:19], v[40:43], v[0:3], 0
    v_mfma_f32_16x16x32_bf16 v[20:23], v[44:47], v[0:3], 0
    v_mfma_f32_16x16x32_bf16 v[32:35], v[48:51], v[0:3], 0
    v_mfma_f32_16x16x32_bf16 v[36:39], v[52:55], v[0:3], 0
    v_mfma_f32_16x16x32_bf16 v[40:43], v[56:59], v[0:3], 0
    v_mfma_f32_16x16x32_bf16 v[44:47], v[60:63], v[0:3], 0
    v_mfma_f32_16x16x32_bf16 v[48:51], v[64:67], v[0:3], 0
    v_mfma_f32_16x16x32_bf16 v[52:55], v[68:71], v[0:3], 0
    v_mfma_f32_16x16x32_bf16 v[56:59], v[72:75], v[0:3], 0
    v_mfma_f32_16x16x32_bf16 v[60:63], v[76:79], v[0:3], 0
    v_mfma_f32_16x16x32_bf16 v[64:67], v[80:83], v[0:3], 0
    v_mfma_f32_16x16x32_bf16 v[68:71], v[84:87], v[0:3], 0
    v_mfma_f32_16x16x32_bf16 v[72:75], v[88:91], v[0:3], 0
    v_mfma_f32_16x16x32_bf16 v[76:79], v[92:95], v[0:3], 0
    s_cmp_lg_u32 s73, 0
    s_cselect_b32 s64, 0x11111111, 0
    s_cselect_b32 s65, 0x11111111, 0
    s_cselect_b32 s66, 0, 0x11111111
    s_cselect_b32 s67, 0, 0x11111111
    s_lshl_b32 s37, s38, 1
    s_add_u32 s37, s37, 0x9E3779B8
    s_mul_i32 s9, s38, 0x01010101
    s_add_u32 s9, s9, 0x5B3C1E87
    s_and_b32 s6, s9, 0xff
    s_bfe_u32 s7, s9, 0x80008
    s_bfe_u32 s8, s9, 0x80010
    s_lshr_b32 s9, s9, 24
    v_cndmask_b32 v24, v8, v13, s[58:59]
    v_cndmask_b32 v24, v24, v18, s[60:61]
    v_cndmask_b32 v24, v24, v23, s[62:63]
    v_cndmask_b32 v28, v12, v9, s[58:59]
    v_cndmask_b32 v28, v28, v22, s[60:61]
    v_cndmask_b32 v28, v28, v19, s[62:63]
    v_cndmask_b32 v29, v16, v21, s[58:59]
    v_cndmask_b32 v29, v29, v10, s[60:61]
    v_cndmask_b32 v29, v29, v15, s[62:63]
    v_cndmask_b32 v30, v20, v17, s[58:59]
    v_cndmask_b32 v30, v30, v14, s[60:61]
    v_cndmask_b32 v30, v30, v11, s[62:63]
    v_add_f32_dpp v24, v28, v24 quad_perm:[1,0,3,2] row_mask:0xf bank_mask:0xf
    s_nop 1
    v_add_f32_dpp v24, v29, v24 quad_perm:[2,3,0,1] row_mask:0xf bank_mask:0xf
    s_nop 1
    v_add_f32_dpp v24, v30, v24 quad_perm:[3,2,1,0] row_mask:0xf bank_mask:0xf
    v_cndmask_b32 v25, v32, v37, s[58:59]
    v_cndmask_b32 v25, v25, v42, s[60:61]
    v_cndmask_b32 v25, v25, v47, s[62:63]
    v_cndmask_b32 v28, v36, v33, s[58:59]
    v_cndmask_b32 v28, v28, v46, s[60:61]
    v_cndmask_b32 v28, v28, v43, s[62:63]
    v_cndmask_b32 v29, v40, v45, s[58:59]
    v_cndmask_b32 v29, v29, v34, s[60:61]
    v_cndmask_b32 v29, v29, v39, s[62:63]
    v_cndmask_b32 v30, v44, v41, s[58:59]
    v_cndmask_b32 v30, v30, v38, s[60:61]
    v_cndmask_b32 v30, v30, v35, s[62:63]
    v_add_f32_dpp v25, v28, v25 quad_perm:[1,0,3,2] row_mask:0xf bank_mask:0xf
    s_nop 1
    v_add_f32_dpp v25, v29, v25 quad_perm:[2,3,0,1] row_mask:0xf bank_mask:0xf
    s_nop 1
    v_add_f32_dpp v25, v30, v25 quad_perm:[3,2,1,0] row_mask:0xf bank_mask:0xf
    v_cndmask_b32 v26, v48, v53, s[58:59]
    v_cndmask_b32 v26, v26, v58, s[60:61]
    v_cndmask_b32 v26, v26, v63, s[62:63]
    v_cndmask_b32 v28, v52, v49, s[58:59]
    v_cndmask_b32 v28, v28, v62, s[60:61]
    v_cndmask_b32 v28, v28, v59, s[62:63]
    v_cndmask_b32 v29, v56, v61, s[58:59]
    v_cndmask_b32 v29, v29, v50, s[60:61]
    v_cndmask_b32 v29, v29, v55, s[62:63]
    v_cndmask_b32 v30, v60, v57, s[58:59]
    v_cndmask_b32 v30, v30, v54, s[60:61]
    v_cndmask_b32 v30, v30, v51, s[62:63]
    v_add_f32_dpp v26, v28, v26 quad_perm:[1,0,3,2] row_mask:0xf bank_mask:0xf
    s_nop 1
    v_add_f32_dpp v26, v29, v26 quad_perm:[2,3,0,1] row_mask:0xf bank_mask:0xf
    s_nop 1
    v_add_f32_dpp v26, v30, v26 quad_perm:[3,2,1,0] row_mask:0xf bank_mask:0xf
    v_cndmask_b32 v27, v64, v69, s[58:59]
    v_cndmask_b32 v27, v27, v74, s[60:61]
    v_cndmask_b32 v27, v27, v79, s[62:63]
    v_cndmask_b32 v28, v68, v65, s[58:59]
    v_cndmask_b32 v28, v28, v78, s[60:61]
    v_cndmask_b32 v28, v28, v75, s[62:63]
    v_cndmask_b32 v29, v72, v77, s[58:59]
    v_cndmask_b32 v29, v29, v66, s[60:61]
    v_cndmask_b32 v29, v29, v71, s[62:63]
    v_cndmask_b32 v30, v76, v73, s[58:59]
    v_cndmask_b32 v30, v30, v70, s[60:61]
    v_cndmask_b32 v30, v30, v67, s[62:63]
    v_add_f32_dpp v27, v28, v27 quad_perm:[1,0,3,2] row_mask:0xf bank_mask:0xf
    s_nop 1
    v_add_f32_dpp v27, v29, v27 quad_perm:[2,3,0,1] row_mask:0xf bank_mask:0xf
    s_nop 1
    v_add_f32_dpp v27, v30, v27 quad_perm:[3,2,1,0] row_mask:0xf bank_mask:0xf
    v_cvt_pk_bf16_f32 v28, v24, v25
    v_lshlrev_b32 v24, 16, v28
    v_and_b32 v25, s72, v28
    v_cvt_pk_bf16_f32 v29, v26, v27
    v_lshlrev_b32 v26, 16, v29
    v_and_b32 v27, s72, v29
    s_mov_b32 s54, 1035273459
    v_mul_f32 v24, s54, v24
    v_mul_f32 v25, s54, v25
    v_mul_f32 v26, s54, v26
    v_mul_f32 v27, s54, v27
    v_cvt_pk_bf16_f32 v28, v24, v25
    v_lshlrev_b32 v24, 16, v28
    v_and_b32 v25, s72, v28
    v_cvt_pk_bf16_f32 v29, v26, v27
    v_lshlrev_b32 v26, 16, v29
    v_and_b32 v27, s72, v29
    v_max3_f32 v28, v24, v25, v26
    v_max_f32 v28, v28, v27
    s_nop 1
    v_max_f32_dpp v28, v28, v28 quad_perm:[1,0,3,2] row_mask:0xf bank_mask:0xf
    s_nop 1
    v_max_f32_dpp v28, v28, v28 quad_perm:[2,3,0,1] row_mask:0xf bank_mask:0xf
    v_mov_b32 v29, v28
    s_nop 1
    v_permlane16_swap_b32 v28, v29
    v_max_f32 v28, v28, v29
    v_mov_b32 v29, v28
    s_nop 1
    v_permlane32_swap_b32 v28, v29
    v_max_f32 v28, v28, v29
    v_min_u32 v28, -2, v28
    ds_write_b32 v164, v28 offset:1280
    s_cmp_eq_u32 s99, 32
    s_cbranch_scc1 Lg_B32
    s_cmp_eq_u32 s99, 31
    s_cbranch_scc1 Lg_B31
    s_cmp_eq_u32 s99, 30
    s_cbranch_scc1 Lg_B30
    s_cmp_eq_u32 s99, 29
    s_cbranch_scc1 Lg_B29
    s_cmp_eq_u32 s99, 28
    s_cbranch_scc1 Lg_B28
    s_cmp_eq_u32 s99, 27
    s_cbranch_scc1 Lg_B27
    s_cmp_eq_u32 s99, 26
    s_cbranch_scc1 Lg_B26
    s_cmp_eq_u32 s99, 25
    s_cbranch_scc1 Lg_B25
    s_cmp_eq_u32 s99, 24
    s_cbranch_scc1 Lg_B24
    s_cmp_eq_u32 s99, 23
    s_cbranch_scc1 Lg_B23
    s_cmp_eq_u32 s99, 22
    s_cbranch_scc1 Lg_B22
Lg_B21:
    s_waitcnt vmcnt(3)
    buffer_load_dwordx4 v[116:119], v5, s[48:51], s55 offen offset:1024 nt
    s_mov_b64 exec, 1
    ds_add_u32 v163, v161 offset:20
    s_mov_b64 exec, -1
Lg_B22:
    s_waitcnt vmcnt(3)
    buffer_load_dwordx4 v[120:123], v5, s[48:51], s55 offen offset:2048 nt
Lg_B23:
    s_waitcnt vmcnt(3)
    buffer_load_dwordx4 v[124:127], v5, s[48:51], s55 offen offset:3072 nt
Lg_B24:
    s_waitcnt vmcnt(3)
    buffer_load_dwordx4 v[128:131], v5, s[48:51], s56 offen offset:0 nt
Lg_B25:
    s_waitcnt vmcnt(3)
    buffer_load_dwordx4 v[132:135], v5, s[48:51], s56 offen offset:1024 nt
Lg_B26:
    s_waitcnt vmcnt(3)
    buffer_load_dwordx4 v[136:139], v5, s[48:51], s56 offen offset:2048 nt
Lg_B27:
    s_waitcnt vmcnt(3)
    buffer_load_dwordx4 v[140:143], v5, s[48:51], s56 offen offset:3072 nt
Lg_B28:
    s_waitcnt vmcnt(3)
    buffer_load_dwordx4 v[144:147], v5, s[48:51], s57 offen offset:0 nt
Lg_B29:
    s_waitcnt vmcnt(3)
    buffer_load_dwordx4 v[148:151], v5, s[48:51], s57 offen offset:1024 nt
Lg_B30:
    s_waitcnt vmcnt(3)
    buffer_load_dwordx4 v[152:155], v5, s[48:51], s57 offen offset:2048 nt
Lg_B31:
    s_waitcnt vmcnt(3)
    buffer_load_dwordx4 v[156:159], v5, s[48:51], s57 offen offset:3072 nt
    s_mov_b64 exec, 1
    ds_add_u32 v163, v161 offset:12
    s_mov_b64 exec, -1
Lg_B32:
    s_waitcnt vmcnt(8)
    s_nop 0
    v_perm_b32 v32, v100, v96, s52
    v_perm_b32 v36, v100, v96, s53
    v_perm_b32 v40, v101, v97, s52
    v_perm_b32 v44, v101, v97, s53
    v_perm_b32 v48, v102, v98, s52
    v_perm_b32 v52, v102, v98, s53
    v_perm_b32 v56, v103, v99, s52
    v_perm_b32 v60, v103, v99, s53
    v_perm_b32 v33, v108, v104, s52
    v_perm_b32 v37, v108, v104, s53
    v_perm_b32 v41, v109, v105, s52
    v_perm_b32 v45, v109, v105, s53
    v_perm_b32 v49, v110, v106, s52
    v_perm_b32 v53, v110, v106, s53
    v_perm_b32 v57, v111, v107, s52
    v_perm_b32 v61, v111, v107, s53
    v_perm_b32 v34, v116, v112, s52
    v_perm_b32 v38, v116, v112, s53
    v_perm_b32 v42, v117, v113, s52
    v_perm_b32 v46, v117, v113, s53
    v_perm_b32 v50, v118, v114, s52
    v_perm_b32 v54, v118, v114, s53
    v_perm_b32 v58, v119, v115, s52
    v_perm_b32 v62, v119, v115, s53
    v_perm_b32 v35, v124, v120, s52
    v_perm_b32 v39, v124, v120, s53
    v_perm_b32 v43, v125, v121, s52
    v_perm_b32 v47, v125, v121, s53
    v_perm_b32 v51, v126, v122, s52
    v_perm_b32 v55, v126, v122, s53
    v_perm_b32 v59, v127, v123, s52
    v_perm_b32 v63, v127, v123, s53
    s_mov_b32 s39, 320000
Lb3_65:
    ds_read_b128 v[8:11], v7 offset:1280
    ds_read_b128 v[12:15], v7 offset:1296
    s_sub_u32 s39, s39, 1
    s_cbranch_scc1 Lb3x_66
    s_waitcnt lgkmcnt(0)
    v_max3_u32 v16, v8, v9, v10
    v_max3_u32 v17, v11, v12, v13
    v_max3_u32 v16, v16, v14, v15
    v_max_u32 v16, v16, v17
    v_cmp_eq_u32 vcc, -1, v16
    s_cbranch_vccnz Lb3_65
Lb3x_66:
    s_mov_b32 s54, 1069066811
    s_waitcnt lgkmcnt(0)
    v_max3_f32 v8, v8, v9, v10
    v_max3_f32 v12, v11, v12, v13
    v_max3_f32 v8, v8, v14, v15
    v_max_f32 v8, v8, v12
    v_mul_f32 v162, s54, v8
    v_fma_f32 v24, v24, s54, -v162
    v_fma_f32 v25, v25, s54, -v162
    v_fma_f32 v26, v26, s54, -v162
    v_fma_f32 v27, v27, s54, -v162
    v_exp_f32 v24, v24
    v_exp_f32 v25, v25
    v_exp_f32 v26, v26
    v_exp_f32 v27, v27
    v_mov_b32_dpp v28, v24 quad_perm:[1,1,3,3] row_mask:0xf bank_mask:0xf
    v_mov_b32_dpp v29, v25 quad_perm:[1,1,3,3] row_mask:0xf bank_mask:0xf
    v_mov_b32_dpp v30, v26 quad_perm:[1,1,3,3] row_mask:0xf bank_mask:0xf
    v_mov_b32_dpp v31, v27 quad_perm:[1,1,3,3] row_mask:0xf bank_mask:0xf
    v_cvt_pk_bf16_f32 v8, v24, v28
    v_cvt_pk_bf16_f32 v10, v25, v29
    v_cvt_pk_bf16_f32 v12, v26, v30
    v_cvt_pk_bf16_f32 v14, v27, v31
    v_mov_b32_dpp v9, v8 quad_perm:[2,2,2,2] row_mask:0xf bank_mask:0xf
    v_mov_b32_dpp v11, v10 quad_perm:[2,2,2,2] row_mask:0xf bank_mask:0xf
    v_mov_b32_dpp v13, v12 quad_perm:[2,2,2,2] row_mask:0xf bank_mask:0xf
    v_mov_b32_dpp v15, v14 quad_perm:[2,2,2,2] row_mask:0xf bank_mask:0xf
    v_mfma_f32_16x16x32_bf16 v[96:99], v[8:11], v[32:35], 0
    v_mfma_f32_16x16x32_bf16 v[100:103], v[8:11], v[36:39], 0
    v_mfma_f32_16x16x32_bf16 v[104:107], v[8:11], v[40:43], 0
    v_mfma_f32_16x16x32_bf16 v[108:111], v[8:11], v[44:47], 0
    v_mfma_f32_16x16x32_bf16 v[112:115], v[8:11], v[48:51], 0
    v_mfma_f32_16x16x32_bf16 v[116:119], v[8:11], v[52:55], 0
    v_mfma_f32_16x16x32_bf16 v[120:123], v[8:11], v[56:59], 0
    v_mfma_f32_16x16x32_bf16 v[124:127], v[8:11], v[60:63], 0
    v_add_f32 v24, v24, v25
    v_add_f32 v26, v26, v27
    v_add_f32 v24, v24, v26
    s_nop 1
    v_add_f32_dpp v24, v24, v24 quad_perm:[1,0,3,2] row_mask:0xf bank_mask:0xf
    s_nop 1
    v_add_f32_dpp v24, v24, v24 quad_perm:[2,3,0,1] row_mask:0xf bank_mask:0xf
    v_mov_b32 v25, v24
    s_nop 1
    v_permlane16_swap_b32 v24, v25
    v_add_f32 v24, v24, v25
    v_mov_b32 v25, v24
    s_nop 1
    v_permlane32_swap_b32 v24, v25
    v_add_f32 v24, v24, v25
    v_min_u32 v24, -2, v24
    v_mov_b32 v31, 0xff
    v_mov_b32 v28, v162
    v_mov_b32 v30, s37
    s_cmp_eq_u32 s3, 7
    s_cselect_b32 s54, 0xffff, 0
    s_and_b32 s68, s64, s54
    s_mov_b32 s69, 0
    s_and_b32 s70, s66, s54
    s_mov_b32 s71, 0
    s_waitcnt vmcnt(4)
    v_perm_b32 v64, v132, v128, s52
    v_perm_b32 v68, v132, v128, s53
    v_perm_b32 v72, v133, v129, s52
    v_perm_b32 v76, v133, v129, s53
    v_perm_b32 v80, v134, v130, s52
    v_perm_b32 v84, v134, v130, s53
    v_perm_b32 v88, v135, v131, s52
    v_perm_b32 v92, v135, v131, s53
    v_perm_b32 v65, v140, v136, s52
    v_perm_b32 v69, v140, v136, s53
    v_perm_b32 v73, v141, v137, s52
    v_perm_b32 v77, v141, v137, s53
    v_perm_b32 v81, v142, v138, s52
    v_perm_b32 v85, v142, v138, s53
    v_perm_b32 v89, v143, v139, s52
    v_perm_b32 v93, v143, v139, s53
    s_waitcnt vmcnt(2)
    v_perm_b32 v66, v148, v144, s52
    v_perm_b32 v70, v148, v144, s53
    v_perm_b32 v74, v149, v145, s52
    v_perm_b32 v78, v149, v145, s53
    v_perm_b32 v82, v150, v146, s52
    v_perm_b32 v86, v150, v146, s53
    v_perm_b32 v90, v151, v147, s52
    v_perm_b32 v94, v151, v147, s53
    s_waitcnt vmcnt(0)
    v_perm_b32 v67, v156, v152, s52
    v_perm_b32 v71, v156, v152, s53
    v_perm_b32 v75, v157, v153, s52
    v_perm_b32 v79, v157, v153, s53
    v_perm_b32 v83, v158, v154, s52
    v_perm_b32 v87, v158, v154, s53
    v_perm_b32 v91, v159, v155, s52
    v_perm_b32 v95, v159, v155, s53
    v_mfma_f32_16x16x32_bf16 v[96:99], v[12:15], v[64:67], v[96:99]
    v_mfma_f32_16x16x32_bf16 v[100:103], v[12:15], v[68:71], v[100:103]
    v_mfma_f32_16x16x32_bf16 v[104:107], v[12:15], v[72:75], v[104:107]
    v_mfma_f32_16x16x32_bf16 v[108:111], v[12:15], v[76:79], v[108:111]
    v_mfma_f32_16x16x32_bf16 v[112:115], v[12:15], v[80:83], v[112:115]
    v_mfma_f32_16x16x32_bf16 v[116:119], v[12:15], v[84:87], v[116:119]
    v_mfma_f32_16x16x32_bf16 v[120:123], v[12:15], v[88:91], v[120:123]
    v_mfma_f32_16x16x32_bf16 v[124:127], v[12:15], v[92:95], v[124:127]
    s_nop 0
    ds_write_b32 v165, v96 offset:0
    ds_write_b32 v165, v100 offset:256
    ds_write_b32 v165, v104 offset:512
    ds_write_b32 v165, v108 offset:768
    ds_write_b32 v165, v112 offset:1024
    ds_write_b32 v165, v116 offset:1280
    ds_write_b32 v165, v120 offset:1536
    ds_write_b32 v165, v124 offset:1792
    ds_write_b32 v164, v24 offset:1408
    s_mov_b32 s39, 320000
Lb4_67:
    ds_read_b128 v[16:19], v7 offset:1408
    ds_read_b128 v[20:23], v7 offset:1424
    ds_read_b128 v[8:11], v166
    ds_read_b128 v[12:15], v166 offset:2080
    s_sub_u32 s39, s39, 1
    s_cbranch_scc1 Lb4x_68
    s_waitcnt lgkmcnt(2)
    v_max3_u32 v24, v16, v17, v18
    v_max3_u32 v25, v19, v20, v21
    v_max3_u32 v24, v24, v22, v23
    v_max_u32 v24, v24, v25
    v_cmp_eq_u32 vcc, -1, v24
    s_waitcnt lgkmcnt(0)
    s_cbranch_vccnz Lb4_67
Lb4x_68:
    s_waitcnt lgkmcnt(0)
    v_add_f32 v8, v8, v12
    v_add_f32 v9, v9, v13
    v_add_f32 v10, v10, v14
    v_add_f32 v11, v11, v15
    v_add_f32_dpp v8, v8, v8 quad_perm:[1,0,3,2] row_mask:0xf bank_mask:0xf
    v_add_f32_dpp v9, v9, v9 quad_perm:[1,0,3,2] row_mask:0xf bank_mask:0xf
    v_add_f32_dpp v10, v10, v10 quad_perm:[1,0,3,2] row_mask:0xf bank_mask:0xf
    v_add_f32_dpp v11, v11, v11 quad_perm:[1,0,3,2] row_mask:0xf bank_mask:0xf
    v_add_f32_dpp v8, v8, v8 quad_perm:[2,3,0,1] row_mask:0xf bank_mask:0xf
    v_add_f32_dpp v9, v9, v9 quad_perm:[2,3,0,1] row_mask:0xf bank_mask:0xf
    v_add_f32_dpp v10, v10, v10 quad_perm:[2,3,0,1] row_mask:0xf bank_mask:0xf
    v_add_f32_dpp v11, v11, v11 quad_perm:[2,3,0,1] row_mask:0xf bank_mask:0xf
    v_bfi_b32 v8, v31, s6, v8
    v_bfi_b32 v9, v31, s7, v9
    v_bfi_b32 v10, v31, s8, v10
    v_bfi_b32 v11, v31, s9, v11
    s_mov_b64 exec, s[64:65]
    buffer_store_dwordx4 v[8:11], v167, s[40:43], 0 offen
    s_mov_b64 exec, s[66:67]
    buffer_store_dwordx4 v[8:11], v167, s[40:43], 0 offen sc1
    s_mov_b64 exec, -1
    s_cmp_lg_u32 s3, 7
    s_cbranch_scc1 Lg_nost
    v_pk_add_f32 v[16:17], v[16:17], v[18:19]
    v_pk_add_f32 v[20:21], v[20:21], v[22:23]
    v_pk_add_f32 v[16:17], v[16:17], v[20:21]
    v_add_f32 v29, v16, v17
    s_mov_b64 exec, s[68:69]
    buffer_store_dwordx3 v[28:30], v160, s[40:43], 0 offen
    s_mov_b64 exec, s[70:71]
    buffer_store_dwordx3 v[28:30], v160, s[40:43], 0 offen sc1
    s_mov_b64 exec, -1
Lg_nost:
    s_mov_b64 exec, 1
    ds_add_u32 v163, v161 offset:16
    s_mov_b64 exec, -1
    s_mov_b64 exec, 1
    ds_add_u32 v163, v161 offset:28
    s_mov_b64 exec, -1
Lg_send:
    s_endpgm
Lg_qk19:
    buffer_load_dwordx4 v[112:115], v5, s[48:51], s55 offen offset:0 nt
    s_mov_b32 s99, 21
    s_branch Lg_QK
Lg_qk20:
    buffer_load_dwordx4 v[116:119], v5, s[48:51], s55 offen offset:1024 nt
    s_mov_b64 exec, 1
    ds_add_u32 v163, v161 offset:20
    s_mov_b64 exec, -1
    s_mov_b32 s99, 22
    s_branch Lg_QK
Lg_qk21:
    buffer_load_dwordx4 v[120:123], v5, s[48:51], s55 offen offset:2048 nt
    s_mov_b32 s99, 23
    s_branch Lg_QK
Lg_qk22:
    buffer_load_dwordx4 v[124:127], v5, s[48:51], s55 offen offset:3072 nt
    s_mov_b32 s99, 24
    s_branch Lg_QK
Lg_qk23:
    buffer_load_dwordx4 v[128:131], v5, s[48:51], s56 offen offset:0 nt
    s_mov_b32 s99, 25
    s_branch Lg_QK
Lg_qk24:
    buffer_load_dwordx4 v[132:135], v5, s[48:51], s56 offen offset:1024 nt
    s_mov_b32 s99, 26
    s_branch Lg_QK
Lg_qk25:
    buffer_load_dwordx4 v[136:139], v5, s[48:51], s56 offen offset:2048 nt
    s_mov_b32 s99, 27
    s_branch Lg_QK
Lg_qk26:
    buffer_load_dwordx4 v[140:143], v5, s[48:51], s56 offen offset:3072 nt
    s_mov_b32 s99, 28
    s_branch Lg_QK
Lg_qk27:
    buffer_load_dwordx4 v[144:147], v5, s[48:51], s57 offen offset:0 nt
    s_mov_b32 s99, 29
    s_branch Lg_QK
Lg_qk28:
    buffer_load_dwordx4 v[148:151], v5, s[48:51], s57 offen offset:1024 nt
    s_mov_b32 s99, 30
    s_branch Lg_QK
Lg_qk29:
    buffer_load_dwordx4 v[152:155], v5, s[48:51], s57 offen offset:2048 nt
    s_mov_b32 s99, 31
    s_branch Lg_QK
Lg_qk30:
    buffer_load_dwordx4 v[156:159], v5, s[48:51], s57 offen offset:3072 nt
    s_mov_b64 exec, 1
    ds_add_u32 v163, v161 offset:12
    s_mov_b64 exec, -1
    s_mov_b32 s99, 32
    s_branch Lg_QK
L_sF:
    buffer_load_dwordx4 v[44:47], v4, s[44:47], s98 offen offset:3072 nt
    s_xor_b32 s55, s98, 262144
    s_xor_b32 s56, s98, 524288
    s_xor_b32 s57, s98, 786432
    buffer_load_dwordx4 v[48:51], v4, s[44:47], s55 offen offset:0 nt
    buffer_load_dwordx4 v[52:55], v4, s[44:47], s55 offen offset:1024 nt
    buffer_load_dwordx4 v[56:59], v4, s[44:47], s55 offen offset:2048 nt
    buffer_load_dwordx4 v[60:63], v4, s[44:47], s55 offen offset:3072 nt
    s_mov_b32 s50, 134217728
    s_mov_b32 s51, 0x20000
    s_mov_b64 s[48:49], s[8:9]
    s_mov_b32 s42, 16777216
    s_mov_b32 s43, 0x20000
    s_mov_b64 s[40:41], s[30:31]
    s_mov_b32 s52, 0x05040100
    s_mov_b32 s53, 0x07060302
    s_mov_b32 s72, 0xffff0000
    v_mov_b32 v163, 0
    v_mov_b32 v161, 1
    s_load_dword s38, s[30:31], 0
    v_cmp_eq_u32 s[58:59], 1, v3
    v_cmp_eq_u32 s[60:61], 2, v3
    v_cmp_eq_u32 s[62:63], 3, v3
    v_lshlrev_b32 v7, 5, v1
    s_lshr_b32 s54, s36, 1
    s_and_b32 s99, s36, 1
    s_mov_b32 s100, 655360
    s_lshl_b32 s101, s33, 11
    s_add_u32 s100, s100, s101
    s_lshl_b32 s101, s54, 7
    s_add_u32 s100, s100, s101
    s_lshl_b32 s101, s35, 5
    s_add_u32 s100, s100, s101
    s_lshl4_add_u32 s100, s99, s100
    v_bfe_u32 v2, v0, 2, 2
    v_lshl_add_u32 v160, v2, 9, s100
    s_lshl_b32 s100, s3, 2
    v_bfe_u32 v2, v0, 2, 2
    v_lshl_add_u32 v164, v2, 5, s100
    s_mov_b32 s100, 16384
    s_mul_i32 s101, s3, 2080
    s_add_u32 s100, s100, s101
    v_lshl_add_u32 v165, v0, 2, s100
    s_mov_b32 s100, 16384
    s_lshl_b32 s101, s3, 8
    s_add_u32 s100, s100, s101
    v_and_b32 v2, 3, v0
    v_mul_u32_u24 v2, 4160, v2
    v_add_u32 v166, s100, v2
    v_lshrrev_b32 v2, 2, v0
    v_lshl_add_u32 v166, v2, 4, v166
    s_lshr_b32 s54, s3, 1
    s_and_b32 s99, s3, 1
    s_mov_b32 s100, 131072
    s_lshl_b32 s101, s33, 16
    s_add_u32 s100, s100, s101
    s_lshl_b32 s101, s36, 11
    s_add_u32 s100, s100, s101
    s_lshl_b32 s101, s54, 9
    s_add_u32 s100, s100, s101
    s_lshl_b32 s101, s99, 7
    s_add_u32 s100, s100, s101
    s_lshl4_add_u32 s100, s35, s100
    v_lshrrev_b32 v2, 4, v0
    v_lshl_add_u32 v167, v2, 14, s100
    v_bfe_u32 v2, v0, 2, 1
    v_lshl_add_u32 v167, v2, 8, v167
    v_bfe_u32 v2, v0, 3, 1
    v_lshl_add_u32 v167, v2, 6, v167
    s_waitcnt vmcnt(7)
    buffer_load_dwordx4 v[64:67], v4, s[44:47], s56 offen offset:0 nt
    s_waitcnt vmcnt(7)
    buffer_load_dwordx4 v[68:71], v4, s[44:47], s56 offen offset:1024 nt
    s_waitcnt vmcnt(7)
    buffer_load_dwordx4 v[72:75], v4, s[44:47], s56 offen offset:2048 nt
    s_waitcnt vmcnt(7)
    buffer_load_dwordx4 v[76:79], v4, s[44:47], s56 offen offset:3072 nt
    s_waitcnt vmcnt(7)
    buffer_load_dwordx4 v[80:83], v4, s[44:47], s57 offen offset:0 nt
    s_waitcnt vmcnt(7)
    buffer_load_dwordx4 v[84:87], v4, s[44:47], s57 offen offset:1024 nt
    s_waitcnt vmcnt(7)
    buffer_load_dwordx4 v[88:91], v4, s[44:47], s57 offen offset:2048 nt
    s_waitcnt vmcnt(7)
    buffer_load_dwordx4 v[92:95], v4, s[44:47], s57 offen offset:3072 nt
    s_waitcnt vmcnt(7)
    buffer_load_dwordx4 v[96:99], v5, s[48:51], s98 offen offset:0 nt
    s_waitcnt vmcnt(7)
    buffer_load_dwordx4 v[100:103], v5, s[48:51], s98 offen offset:1024 nt
    s_waitcnt vmcnt(7)
    buffer_load_dwordx4 v[104:107], v5, s[48:51], s98 offen offset:2048 nt
    s_waitcnt vmcnt(7)
    buffer_load_dwordx4 v[108:111], v5, s[48:51], s98 offen offset:3072 nt
    s_waitcnt vmcnt(7)
    buffer_load_dwordx4 v[112:115], v5, s[48:51], s55 offen offset:0 nt
    s_waitcnt vmcnt(7)
    buffer_load_dwordx4 v[116:119], v5, s[48:51], s55 offen offset:1024 nt
    s_waitcnt vmcnt(7)
    buffer_load_dwordx4 v[120:123], v5, s[48:51], s55 offen offset:2048 nt
    ds_read_b32 v162, v163 offset:8
    s_waitcnt vmcnt(7)
    buffer_load_dwordx4 v[124:127], v5, s[48:51], s55 offen offset:3072 nt
    s_waitcnt lgkmcnt(0)
    v_readfirstlane_b32 s54, v162
    s_nop 0
    s_cmp_ge_u32 s54, 4
    s_cbranch_scc1 Lf_qk23
    ds_read_b32 v162, v163 offset:8
    s_waitcnt vmcnt(7)
    buffer_load_dwordx4 v[128:131], v5, s[48:51], s56 offen offset:0 nt
    s_waitcnt lgkmcnt(0)
    v_readfirstlane_b32 s54, v162
    s_nop 0
    s_cmp_ge_u32 s54, 4
    s_cbranch_scc1 Lf_qk24
    ds_read_b32 v162, v163 offset:8
    s_waitcnt vmcnt(7)
    buffer_load_dwordx4 v[132:135], v5, s[48:51], s56 offen offset:1024 nt
    s_mov_b64 exec, 1
    ds_add_u32 v163, v161 offset:20
    s_mov_b64 exec, -1
    s_waitcnt lgkmcnt(0)
    v_readfirstlane_b32 s54, v162
    s_nop 0
    s_cmp_ge_u32 s54, 4
    s_cbranch_scc1 Lf_qk25
    ds_read_b32 v162, v163 offset:8
    s_waitcnt vmcnt(7)
    buffer_load_dwordx4 v[136:139], v5, s[48:51], s56 offen offset:2048 nt
    s_waitcnt lgkmcnt(0)
    v_readfirstlane_b32 s54, v162
    s_nop 0
    s_cmp_ge_u32 s54, 4
    s_cbranch_scc1 Lf_qk26
    ds_read_b32 v162, v163 offset:8
    s_waitcnt vmcnt(7)
    buffer_load_dwordx4 v[140:143], v5, s[48:51], s56 offen offset:3072 nt
    s_waitcnt lgkmcnt(0)
    v_readfirstlane_b32 s54, v162
    s_nop 0
    s_cmp_ge_u32 s54, 4
    s_cbranch_scc1 Lf_qk27
    ds_read_b32 v162, v163 offset:8
    s_waitcnt vmcnt(7)
    buffer_load_dwordx4 v[144:147], v5, s[48:51], s57 offen offset:0 nt
    s_waitcnt lgkmcnt(0)
    v_readfirstlane_b32 s54, v162
    s_nop 0
    s_cmp_ge_u32 s54, 4
    s_cbranch_scc1 Lf_qk28
    ds_read_b32 v162, v163 offset:8
    s_waitcnt vmcnt(7)
    buffer_load_dwordx4 v[148:151], v5, s[48:51], s57 offen offset:1024 nt
    s_waitcnt lgkmcnt(0)
    v_readfirstlane_b32 s54, v162
    s_nop 0
    s_cmp_ge_u32 s54, 4
    s_cbranch_scc1 Lf_qk29
    ds_read_b32 v162, v163 offset:8
    s_waitcnt vmcnt(7)
    buffer_load_dwordx4 v[152:155], v5, s[48:51], s57 offen offset:2048 nt
    s_waitcnt lgkmcnt(0)
    v_readfirstlane_b32 s54, v162
    s_nop 0
    s_cmp_ge_u32 s54, 4
    s_cbranch_scc1 Lf_qk30
    s_waitcnt vmcnt(7)
    buffer_load_dwordx4 v[156:159], v5, s[48:51], s57 offen offset:3072 nt
    s_mov_b64 exec, 1
    ds_add_u32 v163, v161 offset:12
    s_mov_b64 exec, -1
    s_mov_b32 s99, 32
    s_mov_b32 s39, 320000
Lw_69:
    ds_read_b32 v162, v163 offset:8
    s_sub_u32 s39, s39, 1
    s_cbranch_scc1 Lwx_70
    s_waitcnt lgkmcnt(0)
    v_readfirstlane_b32 s54, v162
    s_nop 0
    s_cmp_lt_u32 s54, 4
    s_cbranch_scc1 Lw_69
Lwx_70:
    s_waitcnt lgkmcnt(0)
Lf_QK:
    ds_read_b128 v[0:3], v6 offset:256
    ds_read_b32 v162, v163 offset:128
    s_waitcnt lgkmcnt(0)
    v_readfirstlane_b32 s73, v162
    v_mfma_f32_16x16x32_bf16 v[8:11], v[32:35], v[0:3], 0
    v_mfma_f32_16x16x32_bf16 v[12:15], v[36:39], v[0:3], 0
    v_mfma_f32_16x16x32_bf16 v[16:19], v[40:43], v[0:3], 0
    v_mfma_f32_16x16x32_bf16 v[20:23], v[44:47], v[0:3], 0
    v_mfma_f32_16x16x32_bf16 v[32:35], v[48:51], v[0:3], 0
    v_mfma_f32_16x16x32_bf16 v[36:39], v[52:55], v[0:3], 0
    v_mfma_f32_16x16x32_bf16 v[40:43], v[56:59], v[0:3], 0
    v_mfma_f32_16x16x32_bf16 v[44:47], v[60:63], v[0:3], 0
    v_mfma_f32_16x16x32_bf16 v[48:51], v[64:67], v[0:3], 0
    v_mfma_f32_16x16x32_bf16 v[52:55], v[68:71], v[0:3], 0
    v_mfma_f32_16x16x32_bf16 v[56:59], v[72:75], v[0:3], 0
    v_mfma_f32_16x16x32_bf16 v[60:63], v[76:79], v[0:3], 0
    v_mfma_f32_16x16x32_bf16 v[64:67], v[80:83], v[0:3], 0
    v_mfma_f32_16x16x32_bf16 v[68:71], v[84:87], v[0:3], 0
    v_mfma_f32_16x16x32_bf16 v[72:75], v[88:91], v[0:3], 0
    v_mfma_f32_16x16x32_bf16 v[76:79], v[92:95], v[0:3], 0
    s_cmp_lg_u32 s73, 0
    s_cselect_b32 s64, 0x11111111, 0
    s_cselect_b32 s65, 0x11111111, 0
    s_cselect_b32 s66, 0, 0x11111111
    s_cselect_b32 s67, 0, 0x11111111
    s_lshl_b32 s37, s38, 1
    s_add_u32 s37, s37, 0x9E3779B8
    s_mul_i32 s9, s38, 0x01010101
    s_add_u32 s9, s9, 0x5B3C1E87
    s_and_b32 s6, s9, 0xff
    s_bfe_u32 s7, s9, 0x80008
    s_bfe_u32 s8, s9, 0x80010
    s_lshr_b32 s9, s9, 24
    v_cndmask_b32 v24, v8, v13, s[58:59]
    v_cndmask_b32 v24, v24, v18, s[60:61]
    v_cndmask_b32 v24, v24, v23, s[62:63]
    v_cndmask_b32 v28, v12, v9, s[58:59]
    v_cndmask_b32 v28, v28, v22, s[60:61]
    v_cndmask_b32 v28, v28, v19, s[62:63]
    v_cndmask_b32 v29, v16, v21, s[58:59]
    v_cndmask_b32 v29, v29, v10, s[60:61]
    v_cndmask_b32 v29, v29, v15, s[62:63]
    v_cndmask_b32 v30, v20, v17, s[58:59]
    v_cndmask_b32 v30, v30, v14, s[60:61]
    v_cndmask_b32 v30, v30, v11, s[62:63]
    v_add_f32_dpp v24, v28, v24 quad_perm:[1,0,3,2] row_mask:0xf bank_mask:0xf
    s_nop 1
    v_add_f32_dpp v24, v29, v24 quad_perm:[2,3,0,1] row_mask:0xf bank_mask:0xf
    s_nop 1
    v_add_f32_dpp v24, v30, v24 quad_perm:[3,2,1,0] row_mask:0xf bank_mask:0xf
    v_cndmask_b32 v25, v32, v37, s[58:59]
    v_cndmask_b32 v25, v25, v42, s[60:61]
    v_cndmask_b32 v25, v25, v47, s[62:63]
    v_cndmask_b32 v28, v36, v33, s[58:59]
    v_cndmask_b32 v28, v28, v46, s[60:61]
    v_cndmask_b32 v28, v28, v43, s[62:63]
    v_cndmask_b32 v29, v40, v45, s[58:59]
    v_cndmask_b32 v29, v29, v34, s[60:61]
    v_cndmask_b32 v29, v29, v39, s[62:63]
    v_cndmask_b32 v30, v44, v41, s[58:59]
    v_cndmask_b32 v30, v30, v38, s[60:61]
    v_cndmask_b32 v30, v30, v35, s[62:63]
    v_add_f32_dpp v25, v28, v25 quad_perm:[1,0,3,2] row_mask:0xf bank_mask:0xf
    s_nop 1
    v_add_f32_dpp v25, v29, v25 quad_perm:[2,3,0,1] row_mask:0xf bank_mask:0xf
    s_nop 1
    v_add_f32_dpp v25, v30, v25 quad_perm:[3,2,1,0] row_mask:0xf bank_mask:0xf
    v_cndmask_b32 v26, v48, v53, s[58:59]
    v_cndmask_b32 v26, v26, v58, s[60:61]
    v_cndmask_b32 v26, v26, v63, s[62:63]
    v_cndmask_b32 v28, v52, v49, s[58:59]
    v_cndmask_b32 v28, v28, v62, s[60:61]
    v_cndmask_b32 v28, v28, v59, s[62:63]
    v_cndmask_b32 v29, v56, v61, s[58:59]
    v_cndmask_b32 v29, v29, v50, s[60:61]
    v_cndmask_b32 v29, v29, v55, s[62:63]
    v_cndmask_b32 v30, v60, v57, s[58:59]
    v_cndmask_b32 v30, v30, v54, s[60:61]
    v_cndmask_b32 v30, v30, v51, s[62:63]
    v_add_f32_dpp v26, v28, v26 quad_perm:[1,0,3,2] row_mask:0xf bank_mask:0xf
    s_nop 1
    v_add_f32_dpp v26, v29, v26 quad_perm:[2,3,0,1] row_mask:0xf bank_mask:0xf
    s_nop 1
    v_add_f32_dpp v26, v30, v26 quad_perm:[3,2,1,0] row_mask:0xf bank_mask:0xf
    v_cndmask_b32 v27, v64, v69, s[58:59]
    v_cndmask_b32 v27, v27, v74, s[60:61]
    v_cndmask_b32 v27, v27, v79, s[62:63]
    v_cndmask_b32 v28, v68, v65, s[58:59]
    v_cndmask_b32 v28, v28, v78, s[60:61]
    v_cndmask_b32 v28, v28, v75, s[62:63]
    v_cndmask_b32 v29, v72, v77, s[58:59]
    v_cndmask_b32 v29, v29, v66, s[60:61]
    v_cndmask_b32 v29, v29, v71, s[62:63]
    v_cndmask_b32 v30, v76, v73, s[58:59]
    v_cndmask_b32 v30, v30, v70, s[60:61]
    v_cndmask_b32 v30, v30, v67, s[62:63]
    v_add_f32_dpp v27, v28, v27 quad_perm:[1,0,3,2] row_mask:0xf bank_mask:0xf
    s_nop 1
    v_add_f32_dpp v27, v29, v27 quad_perm:[2,3,0,1] row_mask:0xf bank_mask:0xf
    s_nop 1
    v_add_f32_dpp v27, v30, v27 quad_perm:[3,2,1,0] row_mask:0xf bank_mask:0xf
    v_cvt_pk_bf16_f32 v28, v24, v25
    v_lshlrev_b32 v24, 16, v28
    v_and_b32 v25, s72, v28
    v_cvt_pk_bf16_f32 v29, v26, v27
    v_lshlrev_b32 v26, 16, v29
    v_and_b32 v27, s72, v29
    s_mov_b32 s54, 1035273459
    v_mul_f32 v24, s54, v24
    v_mul_f32 v25, s54, v25
    v_mul_f32 v26, s54, v26
    v_mul_f32 v27, s54, v27
    v_cvt_pk_bf16_f32 v28, v24, v25
    v_lshlrev_b32 v24, 16, v28
    v_and_b32 v25, s72, v28
    v_cvt_pk_bf16_f32 v29, v26, v27
    v_lshlrev_b32 v26, 16, v29
    v_and_b32 v27, s72, v29
    v_max3_f32 v28, v24, v25, v26
    v_max_f32 v28, v28, v27
    s_nop 1
    v_max_f32_dpp v28, v28, v28 quad_perm:[1,0,3,2] row_mask:0xf bank_mask:0xf
    s_nop 1
    v_max_f32_dpp v28, v28, v28 quad_perm:[2,3,0,1] row_mask:0xf bank_mask:0xf
    v_mov_b32 v29, v28
    s_nop 1
    v_permlane16_swap_b32 v28, v29
    v_max_f32 v28, v28, v29
    v_mov_b32 v29, v28
    s_nop 1
    v_permlane32_swap_b32 v28, v29
    v_max_f32 v28, v28, v29
    v_min_u32 v28, -2, v28
    ds_write_b32 v164, v28 offset:1280
    s_cmp_eq_u32 s99, 32
    s_cbranch_scc1 Lf_B32
    s_cmp_eq_u32 s99, 31
    s_cbranch_scc1 Lf_B31
    s_cmp_eq_u32 s99, 30
    s_cbranch_scc1 Lf_B30
    s_cmp_eq_u32 s99, 29
    s_cbranch_scc1 Lf_B29
    s_cmp_eq_u32 s99, 28
    s_cbranch_scc1 Lf_B28
    s_cmp_eq_u32 s99, 27
    s_cbranch_scc1 Lf_B27
    s_cmp_eq_u32 s99, 26
    s_cbranch_scc1 Lf_B26
Lf_B25:
    s_waitcnt vmcnt(7)
    buffer_load_dwordx4 v[132:135], v5, s[48:51], s56 offen offset:1024 nt
    s_mov_b64 exec, 1
    ds_add_u32 v163, v161 offset:20
    s_mov_b64 exec, -1
Lf_B26:
    s_waitcnt vmcnt(7)
    buffer_load_dwordx4 v[136:139], v5, s[48:51], s56 offen offset:2048 nt
Lf_B27:
    s_waitcnt vmcnt(7)
    buffer_load_dwordx4 v[140:143], v5, s[48:51], s56 offen offset:3072 nt
Lf_B28:
    s_waitcnt vmcnt(7)
    buffer_load_dwordx4 v[144:147], v5, s[48:51], s57 offen offset:0 nt
Lf_B29:
    s_waitcnt vmcnt(7)
    buffer_load_dwordx4 v[148:151], v5, s[48:51], s57 offen offset:1024 nt
Lf_B30:
    s_waitcnt vmcnt(7)
    buffer_load_dwordx4 v[152:155], v5, s[48:51], s57 offen offset:2048 nt
Lf_B31:
    s_waitcnt vmcnt(7)
    buffer_load_dwordx4 v[156:159], v5, s[48:51], s57 offen offset:3072 nt
    s_mov_b64 exec, 1
    ds_add_u32 v163, v161 offset:12
    s_mov_b64 exec, -1
Lf_B32:
    s_waitcnt vmcnt(8)
    s_nop 0
    v_perm_b32 v32, v100, v96, s52
    v_perm_b32 v36, v100, v96, s53
    v_perm_b32 v40, v101, v97, s52
    v_perm_b32 v44, v101, v97, s53
    v_perm_b32 v48, v102, v98, s52
    v_perm_b32 v52, v102, v98, s53
    v_perm_b32 v56, v103, v99, s52
    v_perm_b32 v60, v103, v99, s53
    v_perm_b32 v33, v108, v104, s52
    v_perm_b32 v37, v108, v104, s53
    v_perm_b32 v41, v109, v105, s52
    v_perm_b32 v45, v109, v105, s53
    v_perm_b32 v49, v110, v106, s52
    v_perm_b32 v53, v110, v106, s53
    v_perm_b32 v57, v111, v107, s52
    v_perm_b32 v61, v111, v107, s53
    v_perm_b32 v34, v116, v112, s52
    v_perm_b32 v38, v116, v112, s53
    v_perm_b32 v42, v117, v113, s52
    v_perm_b32 v46, v117, v113, s53
    v_perm_b32 v50, v118, v114, s52
    v_perm_b32 v54, v118, v114, s53
    v_perm_b32 v58, v119, v115, s52
    v_perm_b32 v62, v119, v115, s53
    v_perm_b32 v35, v124, v120, s52
    v_perm_b32 v39, v124, v120, s53
    v_perm_b32 v43, v125, v121, s52
    v_perm_b32 v47, v125, v121, s53
    v_perm_b32 v51, v126, v122, s52
    v_perm_b32 v55, v126, v122, s53
    v_perm_b32 v59, v127, v123, s52
    v_perm_b32 v63, v127, v123, s53
    s_mov_b32 s39, 320000
Lb3_71:
    ds_read_b128 v[8:11], v7 offset:1280
    ds_read_b128 v[12:15], v7 offset:1296
    s_sub_u32 s39, s39, 1
    s_cbranch_scc1 Lb3x_72
    s_waitcnt lgkmcnt(0)
    v_max3_u32 v16, v8, v9, v10
    v_max3_u32 v17, v11, v12, v13
    v_max3_u32 v16, v16, v14, v15
    v_max_u32 v16, v16, v17
    v_cmp_eq_u32 vcc, -1, v16
    s_cbranch_vccnz Lb3_71
Lb3x_72:
    s_mov_b32 s54, 1069066811
    s_waitcnt lgkmcnt(0)
    v_max3_f32 v8, v8, v9, v10
    v_max3_f32 v12, v11, v12, v13
    v_max3_f32 v8, v8, v14, v15
    v_max_f32 v8, v8, v12
    v_mul_f32 v162, s54, v8
    v_fma_f32 v24, v24, s54, -v162
    v_fma_f32 v25, v25, s54, -v162
    v_fma_f32 v26, v26, s54, -v162
    v_fma_f32 v27, v27, s54, -v162
    v_exp_f32 v24, v24
    v_exp_f32 v25, v25
    v_exp_f32 v26, v26
    v_exp_f32 v27, v27
    v_mov_b32_dpp v28, v24 quad_perm:[1,1,3,3] row_mask:0xf bank_mask:0xf
    v_mov_b32_dpp v29, v25 quad_perm:[1,1,3,3] row_mask:0xf bank_mask:0xf
    v_mov_b32_dpp v30, v26 quad_perm:[1,1,3,3] row_mask:0xf bank_mask:0xf
    v_mov_b32_dpp v31, v27 quad_perm:[1,1,3,3] row_mask:0xf bank_mask:0xf
    v_cvt_pk_bf16_f32 v8, v24, v28
    v_cvt_pk_bf16_f32 v10, v25, v29
    v_cvt_pk_bf16_f32 v12, v26, v30
    v_cvt_pk_bf16_f32 v14, v27, v31
    v_mov_b32_dpp v9, v8 quad_perm:[2,2,2,2] row_mask:0xf bank_mask:0xf
    v_mov_b32_dpp v11, v10 quad_perm:[2,2,2,2] row_mask:0xf bank_mask:0xf
    v_mov_b32_dpp v13, v12 quad_perm:[2,2,2,2] row_mask:0xf bank_mask:0xf
    v_mov_b32_dpp v15, v14 quad_perm:[2,2,2,2] row_mask:0xf bank_mask:0xf
    v_mfma_f32_16x16x32_bf16 v[96:99], v[8:11], v[32:35], 0
    v_mfma_f32_16x16x32_bf16 v[100:103], v[8:11], v[36:39], 0
    v_mfma_f32_16x16x32_bf16 v[104:107], v[8:11], v[40:43], 0
    v_mfma_f32_16x16x32_bf16 v[108:111], v[8:11], v[44:47], 0
    v_mfma_f32_16x16x32_bf16 v[112:115], v[8:11], v[48:51], 0
    v_mfma_f32_16x16x32_bf16 v[116:119], v[8:11], v[52:55], 0
    v_mfma_f32_16x16x32_bf16 v[120:123], v[8:11], v[56:59], 0
    v_mfma_f32_16x16x32_bf16 v[124:127], v[8:11], v[60:63], 0
    v_add_f32 v24, v24, v25
    v_add_f32 v26, v26, v27
    v_add_f32 v24, v24, v26
    s_nop 1
    v_add_f32_dpp v24, v24, v24 quad_perm:[1,0,3,2] row_mask:0xf bank_mask:0xf
    s_nop 1
    v_add_f32_dpp v24, v24, v24 quad_perm:[2,3,0,1] row_mask:0xf bank_mask:0xf
    v_mov_b32 v25, v24
    s_nop 1
    v_permlane16_swap_b32 v24, v25
    v_add_f32 v24, v24, v25
    v_mov_b32 v25, v24
    s_nop 1
    v_permlane32_swap_b32 v24, v25
    v_add_f32 v24, v24, v25
    v_min_u32 v24, -2, v24
    v_mov_b32 v31, 0xff
    v_mov_b32 v28, v162
    v_mov_b32 v30, s37
    s_cmp_eq_u32 s3, 7
    s_cselect_b32 s54, 0xffff, 0
    s_and_b32 s68, s64, s54
    s_mov_b32 s69, 0
    s_and_b32 s70, s66, s54
    s_mov_b32 s71, 0
    s_waitcnt vmcnt(4)
    v_perm_b32 v64, v132, v128, s52
    v_perm_b32 v68, v132, v128, s53
    v_perm_b32 v72, v133, v129, s52
    v_perm_b32 v76, v133, v129, s53
    v_perm_b32 v80, v134, v130, s52
    v_perm_b32 v84, v134, v130, s53
    v_perm_b32 v88, v135, v131, s52
    v_perm_b32 v92, v135, v131, s53
    v_perm_b32 v65, v140, v136, s52
    v_perm_b32 v69, v140, v136, s53
    v_perm_b32 v73, v141, v137, s52
    v_perm_b32 v77, v141, v137, s53
    v_perm_b32 v81, v142, v138, s52
    v_perm_b32 v85, v142, v138, s53
    v_perm_b32 v89, v143, v139, s52
    v_perm_b32 v93, v143, v139, s53
    s_waitcnt vmcnt(2)
    v_perm_b32 v66, v148, v144, s52
    v_perm_b32 v70, v148, v144, s53
    v_perm_b32 v74, v149, v145, s52
    v_perm_b32 v78, v149, v145, s53
    v_perm_b32 v82, v150, v146, s52
    v_perm_b32 v86, v150, v146, s53
    v_perm_b32 v90, v151, v147, s52
    v_perm_b32 v94, v151, v147, s53
    s_waitcnt vmcnt(0)
    v_perm_b32 v67, v156, v152, s52
    v_perm_b32 v71, v156, v152, s53
    v_perm_b32 v75, v157, v153, s52
    v_perm_b32 v79, v157, v153, s53
    v_perm_b32 v83, v158, v154, s52
    v_perm_b32 v87, v158, v154, s53
    v_perm_b32 v91, v159, v155, s52
    v_perm_b32 v95, v159, v155, s53
    v_mfma_f32_16x16x32_bf16 v[96:99], v[12:15], v[64:67], v[96:99]
    v_mfma_f32_16x16x32_bf16 v[100:103], v[12:15], v[68:71], v[100:103]
    v_mfma_f32_16x16x32_bf16 v[104:107], v[12:15], v[72:75], v[104:107]
    v_mfma_f32_16x16x32_bf16 v[108:111], v[12:15], v[76:79], v[108:111]
    v_mfma_f32_16x16x32_bf16 v[112:115], v[12:15], v[80:83], v[112:115]
    v_mfma_f32_16x16x32_bf16 v[116:119], v[12:15], v[84:87], v[116:119]
    v_mfma_f32_16x16x32_bf16 v[120:123], v[12:15], v[88:91], v[120:123]
    v_mfma_f32_16x16x32_bf16 v[124:127], v[12:15], v[92:95], v[124:127]
    s_nop 0
    ds_write_b32 v165, v96 offset:0
    ds_write_b32 v165, v100 offset:256
    ds_write_b32 v165, v104 offset:512
    ds_write_b32 v165, v108 offset:768
    ds_write_b32 v165, v112 offset:1024
    ds_write_b32 v165, v116 offset:1280
    ds_write_b32 v165, v120 offset:1536
    ds_write_b32 v165, v124 offset:1792
    ds_write_b32 v164, v24 offset:1408
    s_mov_b32 s39, 320000
Lb4_73:
    ds_read_b128 v[16:19], v7 offset:1408
    ds_read_b128 v[20:23], v7 offset:1424
    ds_read_b128 v[8:11], v166
    ds_read_b128 v[12:15], v166 offset:2080
    s_sub_u32 s39, s39, 1
    s_cbranch_scc1 Lb4x_74
    s_waitcnt lgkmcnt(2)
    v_max3_u32 v24, v16, v17, v18
    v_max3_u32 v25, v19, v20, v21
    v_max3_u32 v24, v24, v22, v23
    v_max_u32 v24, v24, v25
    v_cmp_eq_u32 vcc, -1, v24
    s_waitcnt lgkmcnt(0)
    s_cbranch_vccnz Lb4_73
Lb4x_74:
    s_waitcnt lgkmcnt(0)
    v_add_f32 v8, v8, v12
    v_add_f32 v9, v9, v13
    v_add_f32 v10, v10, v14
    v_add_f32 v11, v11, v15
    v_add_f32_dpp v8, v8, v8 quad_perm:[1,0,3,2] row_mask:0xf bank_mask:0xf
    v_add_f32_dpp v9, v9, v9 quad_perm:[1,0,3,2] row_mask:0xf bank_mask:0xf
    v_add_f32_dpp v10, v10, v10 quad_perm:[1,0,3,2] row_mask:0xf bank_mask:0xf
    v_add_f32_dpp v11, v11, v11 quad_perm:[1,0,3,2] row_mask:0xf bank_mask:0xf
    v_add_f32_dpp v8, v8, v8 quad_perm:[2,3,0,1] row_mask:0xf bank_mask:0xf
    v_add_f32_dpp v9, v9, v9 quad_perm:[2,3,0,1] row_mask:0xf bank_mask:0xf
    v_add_f32_dpp v10, v10, v10 quad_perm:[2,3,0,1] row_mask:0xf bank_mask:0xf
    v_add_f32_dpp v11, v11, v11 quad_perm:[2,3,0,1] row_mask:0xf bank_mask:0xf
    v_bfi_b32 v8, v31, s6, v8
    v_bfi_b32 v9, v31, s7, v9
    v_bfi_b32 v10, v31, s8, v10
    v_bfi_b32 v11, v31, s9, v11
    s_mov_b64 exec, s[64:65]
    buffer_store_dwordx4 v[8:11], v167, s[40:43], 0 offen
    s_mov_b64 exec, s[66:67]
    buffer_store_dwordx4 v[8:11], v167, s[40:43], 0 offen sc1
    s_mov_b64 exec, -1
    s_cmp_lg_u32 s3, 7
    s_cbranch_scc1 Lf_nost
    v_pk_add_f32 v[16:17], v[16:17], v[18:19]
    v_pk_add_f32 v[20:21], v[20:21], v[22:23]
    v_pk_add_f32 v[16:17], v[16:17], v[20:21]
    v_add_f32 v29, v16, v17
    s_mov_b64 exec, s[68:69]
    buffer_store_dwordx3 v[28:30], v160, s[40:43], 0 offen
    s_mov_b64 exec, s[70:71]
    buffer_store_dwordx3 v[28:30], v160, s[40:43], 0 offen sc1
    s_mov_b64 exec, -1
Lf_nost:
    s_mov_b64 exec, 1
    ds_add_u32 v163, v161 offset:16
    s_mov_b64 exec, -1
    s_mov_b64 exec, 1
    ds_add_u32 v163, v161 offset:28
    s_mov_b64 exec, -1
Lf_send:
    s_endpgm
Lf_qk23:
    buffer_load_dwordx4 v[128:131], v5, s[48:51], s56 offen offset:0 nt
    s_mov_b32 s99, 25
    s_branch Lf_QK
Lf_qk24:
    buffer_load_dwordx4 v[132:135], v5, s[48:51], s56 offen offset:1024 nt
    s_mov_b64 exec, 1
    ds_add_u32 v163, v161 offset:20
    s_mov_b64 exec, -1
    s_mov_b32 s99, 26
    s_branch Lf_QK
Lf_qk25:
    buffer_load_dwordx4 v[136:139], v5, s[48:51], s56 offen offset:2048 nt
    s_mov_b32 s99, 27
    s_branch Lf_QK
Lf_qk26:
    buffer_load_dwordx4 v[140:143], v5, s[48:51], s56 offen offset:3072 nt
    s_mov_b32 s99, 28
    s_branch Lf_QK
Lf_qk27:
    buffer_load_dwordx4 v[144:147], v5, s[48:51], s57 offen offset:0 nt
    s_mov_b32 s99, 29
    s_branch Lf_QK
Lf_qk28:
    buffer_load_dwordx4 v[148:151], v5, s[48:51], s57 offen offset:1024 nt
    s_mov_b32 s99, 30
    s_branch Lf_QK
Lf_qk29:
    buffer_load_dwordx4 v[152:155], v5, s[48:51], s57 offen offset:2048 nt
    s_mov_b32 s99, 31
    s_branch Lf_QK
Lf_qk30:
    buffer_load_dwordx4 v[156:159], v5, s[48:51], s57 offen offset:3072 nt
    s_mov_b64 exec, 1
    ds_add_u32 v163, v161 offset:12
    s_mov_b64 exec, -1
    s_mov_b32 s99, 32
    s_branch Lf_QK
L_sH:
    buffer_load_dwordx4 v[44:47], v4, s[44:47], s98 offen offset:3072 nt
    s_xor_b32 s55, s98, 262144
    s_xor_b32 s56, s98, 524288
    s_xor_b32 s57, s98, 786432
    buffer_load_dwordx4 v[48:51], v4, s[44:47], s55 offen offset:0 nt
    buffer_load_dwordx4 v[52:55], v4, s[44:47], s55 offen offset:1024 nt
    buffer_load_dwordx4 v[56:59], v4, s[44:47], s55 offen offset:2048 nt
    buffer_load_dwordx4 v[60:63], v4, s[44:47], s55 offen offset:3072 nt
    s_mov_b32 s50, 134217728
    s_mov_b32 s51, 0x20000
    s_mov_b64 s[48:49], s[8:9]
    s_mov_b32 s42, 16777216
    s_mov_b32 s43, 0x20000
    s_mov_b64 s[40:41], s[30:31]
    s_mov_b32 s52, 0x05040100
    s_mov_b32 s53, 0x07060302
    s_mov_b32 s72, 0xffff0000
    v_mov_b32 v163, 0
    v_mov_b32 v161, 1
    s_load_dword s38, s[30:31], 0
    s_barrier
    v_cmp_eq_u32 s[58:59], 1, v3
    v_cmp_eq_u32 s[60:61], 2, v3
    v_cmp_eq_u32 s[62:63], 3, v3
    v_lshlrev_b32 v7, 5, v1
    s_lshr_b32 s54, s36, 1
    s_and_b32 s99, s36, 1
    s_mov_b32 s100, 655360
    s_lshl_b32 s101, s33, 11
    s_add_u32 s100, s100, s101
    s_lshl_b32 s101, s54, 7
    s_add_u32 s100, s100, s101
    s_lshl_b32 s101, s35, 5
    s_add_u32 s100, s100, s101
    s_lshl4_add_u32 s100, s99, s100
    v_bfe_u32 v2, v0, 2, 2
    v_lshl_add_u32 v160, v2, 9, s100
    s_lshl_b32 s100, s3, 2
    v_bfe_u32 v2, v0, 2, 2
    v_lshl_add_u32 v164, v2, 5, s100
    s_mov_b32 s100, 16384
    s_mul_i32 s101, s3, 2080
    s_add_u32 s100, s100, s101
    v_lshl_add_u32 v165, v0, 2, s100
    s_mov_b32 s100, 16384
    s_lshl_b32 s101, s3, 8
    s_add_u32 s100, s100, s101
    v_and_b32 v2, 3, v0
    v_mul_u32_u24 v2, 4160, v2
    v_add_u32 v166, s100, v2
    v_lshrrev_b32 v2, 2, v0
    v_lshl_add_u32 v166, v2, 4, v166
    s_lshr_b32 s54, s3, 1
    s_and_b32 s99, s3, 1
    s_mov_b32 s100, 131072
    s_lshl_b32 s101, s33, 16
    s_add_u32 s100, s100, s101
    s_lshl_b32 s101, s36, 11
    s_add_u32 s100, s100, s101
    s_lshl_b32 s101, s54, 9
    s_add_u32 s100, s100, s101
    s_lshl_b32 s101, s99, 7
    s_add_u32 s100, s100, s101
    s_lshl4_add_u32 s100, s35, s100
    v_lshrrev_b32 v2, 4, v0
    v_lshl_add_u32 v167, v2, 14, s100
    v_bfe_u32 v2, v0, 2, 1
    v_lshl_add_u32 v167, v2, 8, v167
    v_bfe_u32 v2, v0, 3, 1
    v_lshl_add_u32 v167, v2, 6, v167
    s_waitcnt vmcnt(0)
    buffer_load_dwordx4 v[64:67], v4, s[44:47], s56 offen offset:0 nt
    s_mov_b32 s39, 320000
Lw_75:
    ds_read_b32 v162, v163 offset:24
    s_sub_u32 s39, s39, 1
    s_cbranch_scc1 Lwx_76
    s_sleep 2
    s_waitcnt lgkmcnt(0)
    v_readfirstlane_b32 s54, v162
    s_nop 0
    s_cmp_lt_u32 s54, 4
    s_cbranch_scc1 Lw_75
Lwx_76:
    s_waitcnt lgkmcnt(0)
    s_waitcnt vmcnt(5)
    buffer_load_dwordx4 v[68:71], v4, s[44:47], s56 offen offset:1024 nt
    s_waitcnt vmcnt(5)
    buffer_load_dwordx4 v[72:75], v4, s[44:47], s56 offen offset:2048 nt
    s_waitcnt vmcnt(5)
    buffer_load_dwordx4 v[76:79], v4, s[44:47], s56 offen offset:3072 nt
    s_waitcnt vmcnt(5)
    buffer_load_dwordx4 v[80:83], v4, s[44:47], s57 offen offset:0 nt
    s_waitcnt vmcnt(5)
    buffer_load_dwordx4 v[84:87], v4, s[44:47], s57 offen offset:1024 nt
    s_waitcnt vmcnt(5)
    buffer_load_dwordx4 v[88:91], v4, s[44:47], s57 offen offset:2048 nt
    s_waitcnt vmcnt(5)
    buffer_load_dwordx4 v[92:95], v4, s[44:47], s57 offen offset:3072 nt
    s_waitcnt vmcnt(5)
    buffer_load_dwordx4 v[96:99], v5, s[48:51], s98 offen offset:0 nt
    s_waitcnt vmcnt(5)
    buffer_load_dwordx4 v[100:103], v5, s[48:51], s98 offen offset:1024 nt
    s_waitcnt vmcnt(5)
    buffer_load_dwordx4 v[104:107], v5, s[48:51], s98 offen offset:2048 nt
    s_waitcnt vmcnt(5)
    buffer_load_dwordx4 v[108:111], v5, s[48:51], s98 offen offset:3072 nt
    s_waitcnt vmcnt(5)
    buffer_load_dwordx4 v[112:115], v5, s[48:51], s55 offen offset:0 nt
    ds_read_b32 v162, v163 offset:8
    s_waitcnt vmcnt(5)
    buffer_load_dwordx4 v[116:119], v5, s[48:51], s55 offen offset:1024 nt
    s_waitcnt lgkmcnt(0)
    v_readfirstlane_b32 s54, v162
    s_nop 0
    s_cmp_ge_u32 s54, 4
    s_cbranch_scc1 Lh_qk21
    ds_read_b32 v162, v163 offset:8
    s_waitcnt vmcnt(5)
    buffer_load_dwordx4 v[120:123], v5, s[48:51], s55 offen offset:2048 nt
    s_mov_b64 exec, 1
    ds_add_u32 v163, v161 offset:20
    s_mov_b64 exec, -1
    s_waitcnt lgkmcnt(0)
    v_readfirstlane_b32 s54, v162
    s_nop 0
    s_cmp_ge_u32 s54, 4
    s_cbranch_scc1 Lh_qk22
    ds_read_b32 v162, v163 offset:8
    s_waitcnt vmcnt(5)
    buffer_load_dwordx4 v[124:127], v5, s[48:51], s55 offen offset:3072 nt
    s_waitcnt lgkmcnt(0)
    v_readfirstlane_b32 s54, v162
    s_nop 0
    s_cmp_ge_u32 s54, 4
    s_cbranch_scc1 Lh_qk23
    ds_read_b32 v162, v163 offset:8
    s_waitcnt vmcnt(5)
    buffer_load_dwordx4 v[128:131], v5, s[48:51], s56 offen offset:0 nt
    s_waitcnt lgkmcnt(0)
    v_readfirstlane_b32 s54, v162
    s_nop 0
    s_cmp_ge_u32 s54, 4
    s_cbranch_scc1 Lh_qk24
    ds_read_b32 v162, v163 offset:8
    s_waitcnt vmcnt(5)
    buffer_load_dwordx4 v[132:135], v5, s[48:51], s56 offen offset:1024 nt
    s_waitcnt lgkmcnt(0)
    v_readfirstlane_b32 s54, v162
    s_nop 0
    s_cmp_ge_u32 s54, 4
    s_cbranch_scc1 Lh_qk25
    ds_read_b32 v162, v163 offset:8
    s_waitcnt vmcnt(5)
    buffer_load_dwordx4 v[136:139], v5, s[48:51], s56 offen offset:2048 nt
    s_waitcnt lgkmcnt(0)
    v_readfirstlane_b32 s54, v162
    s_nop 0
    s_cmp_ge_u32 s54, 4
    s_cbranch_scc1 Lh_qk26
    ds_read_b32 v162, v163 offset:8
    s_waitcnt vmcnt(5)
    buffer_load_dwordx4 v[140:143], v5, s[48:51], s56 offen offset:3072 nt
    s_waitcnt lgkmcnt(0)
    v_readfirstlane_b32 s54, v162
    s_nop 0
    s_cmp_ge_u32 s54, 4
    s_cbranch_scc1 Lh_qk27
    ds_read_b32 v162, v163 offset:8
    s_waitcnt vmcnt(5)
    buffer_load_dwordx4 v[144:147], v5, s[48:51], s57 offen offset:0 nt
    s_waitcnt lgkmcnt(0)
    v_readfirstlane_b32 s54, v162
    s_nop 0
    s_cmp_ge_u32 s54, 4
    s_cbranch_scc1 Lh_qk28
    ds_read_b32 v162, v163 offset:8
    s_waitcnt vmcnt(5)
    buffer_load_dwordx4 v[148:151], v5, s[48:51], s57 offen offset:1024 nt
    s_waitcnt lgkmcnt(0)
    v_readfirstlane_b32 s54, v162
    s_nop 0
    s_cmp_ge_u32 s54, 4
    s_cbranch_scc1 Lh_qk29
    ds_read_b32 v162, v163 offset:8
    s_waitcnt vmcnt(5)
    buffer_load_dwordx4 v[152:155], v5, s[48:51], s57 offen offset:2048 nt
    s_waitcnt lgkmcnt(0)
    v_readfirstlane_b32 s54, v162
    s_nop 0
    s_cmp_ge_u32 s54, 4
    s_cbranch_scc1 Lh_qk30
    s_waitcnt vmcnt(5)
    buffer_load_dwordx4 v[156:159], v5, s[48:51], s57 offen offset:3072 nt
    s_mov_b64 exec, 1
    ds_add_u32 v163, v161 offset:12
    s_mov_b64 exec, -1
    s_mov_b32 s99, 32
    s_mov_b32 s39, 320000
Lw_77:
    ds_read_b32 v162, v163 offset:8
    s_sub_u32 s39, s39, 1
    s_cbranch_scc1 Lwx_78
    s_waitcnt lgkmcnt(0)
    v_readfirstlane_b32 s54, v162
    s_nop 0
    s_cmp_lt_u32 s54, 4
    s_cbranch_scc1 Lw_77
Lwx_78:
    s_waitcnt lgkmcnt(0)
Lh_QK:
    ds_read_b128 v[0:3], v6 offset:256
    ds_read_b32 v162, v163 offset:128
    s_waitcnt lgkmcnt(0)
    v_readfirstlane_b32 s73, v162
    v_mfma_f32_16x16x32_bf16 v[8:11], v[32:35], v[0:3], 0
    v_mfma_f32_16x16x32_bf16 v[12:15], v[36:39], v[0:3], 0
    v_mfma_f32_16x16x32_bf16 v[16:19], v[40:43], v[0:3], 0
    v_mfma_f32_16x16x32_bf16 v[20:23], v[44:47], v[0:3], 0
    v_mfma_f32_16x16x32_bf16 v[32:35], v[48:51], v[0:3], 0
    v_mfma_f32_16x16x32_bf16 v[36:39], v[52:55], v[0:3], 0
    v_mfma_f32_16x16x32_bf16 v[40:43], v[56:59], v[0:3], 0
    v_mfma_f32_16x16x32_bf16 v[44:47], v[60:63], v[0:3], 0
    v_mfma_f32_16x16x32_bf16 v[48:51], v[64:67], v[0:3], 0
    v_mfma_f32_16x16x32_bf16 v[52:55], v[68:71], v[0:3], 0
    v_mfma_f32_16x16x32_bf16 v[56:59], v[72:75], v[0:3], 0
    v_mfma_f32_16x16x32_bf16 v[60:63], v[76:79], v[0:3], 0
    v_mfma_f32_16x16x32_bf16 v[64:67], v[80:83], v[0:3], 0
    v_mfma_f32_16x16x32_bf16 v[68:71], v[84:87], v[0:3], 0
    v_mfma_f32_16x16x32_bf16 v[72:75], v[88:91], v[0:3], 0
    v_mfma_f32_16x16x32_bf16 v[76:79], v[92:95], v[0:3], 0
    s_cmp_lg_u32 s73, 0
    s_cselect_b32 s64, 0x11111111, 0
    s_cselect_b32 s65, 0x11111111, 0
    s_cselect_b32 s66, 0, 0x11111111
    s_cselect_b32 s67, 0, 0x11111111
    s_lshl_b32 s37, s38, 1
    s_add_u32 s37, s37, 0x9E3779B8
    s_mul_i32 s9, s38, 0x01010101
    s_add_u32 s9, s9, 0x5B3C1E87
    s_and_b32 s6, s9, 0xff
    s_bfe_u32 s7, s9, 0x80008
    s_bfe_u32 s8, s9, 0x80010
    s_lshr_b32 s9, s9, 24
    v_cndmask_b32 v24, v8, v13, s[58:59]
    v_cndmask_b32 v24, v24, v18, s[60:61]
    v_cndmask_b32 v24, v24, v23, s[62:63]
    v_cndmask_b32 v28, v12, v9, s[58:59]
    v_cndmask_b32 v28, v28, v22, s[60:61]
    v_cndmask_b32 v28, v28, v19, s[62:63]
    v_cndmask_b32 v29, v16, v21, s[58:59]
    v_cndmask_b32 v29, v29, v10, s[60:61]
    v_cndmask_b32 v29, v29, v15, s[62:63]
    v_cndmask_b32 v30, v20, v17, s[58:59]
    v_cndmask_b32 v30, v30, v14, s[60:61]
    v_cndmask_b32 v30, v30, v11, s[62:63]
    v_add_f32_dpp v24, v28, v24 quad_perm:[1,0,3,2] row_mask:0xf bank_mask:0xf
    s_nop 1
    v_add_f32_dpp v24, v29, v24 quad_perm:[2,3,0,1] row_mask:0xf bank_mask:0xf
    s_nop 1
    v_add_f32_dpp v24, v30, v24 quad_perm:[3,2,1,0] row_mask:0xf bank_mask:0xf
    v_cndmask_b32 v25, v32, v37, s[58:59]
    v_cndmask_b32 v25, v25, v42, s[60:61]
    v_cndmask_b32 v25, v25, v47, s[62:63]
    v_cndmask_b32 v28, v36, v33, s[58:59]
    v_cndmask_b32 v28, v28, v46, s[60:61]
    v_cndmask_b32 v28, v28, v43, s[62:63]
    v_cndmask_b32 v29, v40, v45, s[58:59]
    v_cndmask_b32 v29, v29, v34, s[60:61]
    v_cndmask_b32 v29, v29, v39, s[62:63]
    v_cndmask_b32 v30, v44, v41, s[58:59]
    v_cndmask_b32 v30, v30, v38, s[60:61]
    v_cndmask_b32 v30, v30, v35, s[62:63]
    v_add_f32_dpp v25, v28, v25 quad_perm:[1,0,3,2] row_mask:0xf bank_mask:0xf
    s_nop 1
    v_add_f32_dpp v25, v29, v25 quad_perm:[2,3,0,1] row_mask:0xf bank_mask:0xf
    s_nop 1
    v_add_f32_dpp v25, v30, v25 quad_perm:[3,2,1,0] row_mask:0xf bank_mask:0xf
    v_cndmask_b32 v26, v48, v53, s[58:59]
    v_cndmask_b32 v26, v26, v58, s[60:61]
    v_cndmask_b32 v26, v26, v63, s[62:63]
    v_cndmask_b32 v28, v52, v49, s[58:59]
    v_cndmask_b32 v28, v28, v62, s[60:61]
    v_cndmask_b32 v28, v28, v59, s[62:63]
    v_cndmask_b32 v29, v56, v61, s[58:59]
    v_cndmask_b32 v29, v29, v50, s[60:61]
    v_cndmask_b32 v29, v29, v55, s[62:63]
    v_cndmask_b32 v30, v60, v57, s[58:59]
    v_cndmask_b32 v30, v30, v54, s[60:61]
    v_cndmask_b32 v30, v30, v51, s[62:63]
    v_add_f32_dpp v26, v28, v26 quad_perm:[1,0,3,2] row_mask:0xf bank_mask:0xf
    s_nop 1
    v_add_f32_dpp v26, v29, v26 quad_perm:[2,3,0,1] row_mask:0xf bank_mask:0xf
    s_nop 1
    v_add_f32_dpp v26, v30, v26 quad_perm:[3,2,1,0] row_mask:0xf bank_mask:0xf
    v_cndmask_b32 v27, v64, v69, s[58:59]
    v_cndmask_b32 v27, v27, v74, s[60:61]
    v_cndmask_b32 v27, v27, v79, s[62:63]
    v_cndmask_b32 v28, v68, v65, s[58:59]
    v_cndmask_b32 v28, v28, v78, s[60:61]
    v_cndmask_b32 v28, v28, v75, s[62:63]
    v_cndmask_b32 v29, v72, v77, s[58:59]
    v_cndmask_b32 v29, v29, v66, s[60:61]
    v_cndmask_b32 v29, v29, v71, s[62:63]
    v_cndmask_b32 v30, v76, v73, s[58:59]
    v_cndmask_b32 v30, v30, v70, s[60:61]
    v_cndmask_b32 v30, v30, v67, s[62:63]
    v_add_f32_dpp v27, v28, v27 quad_perm:[1,0,3,2] row_mask:0xf bank_mask:0xf
    s_nop 1
    v_add_f32_dpp v27, v29, v27 quad_perm:[2,3,0,1] row_mask:0xf bank_mask:0xf
    s_nop 1
    v_add_f32_dpp v27, v30, v27 quad_perm:[3,2,1,0] row_mask:0xf bank_mask:0xf
    v_cvt_pk_bf16_f32 v28, v24, v25
    v_lshlrev_b32 v24, 16, v28
    v_and_b32 v25, s72, v28
    v_cvt_pk_bf16_f32 v29, v26, v27
    v_lshlrev_b32 v26, 16, v29
    v_and_b32 v27, s72, v29
    s_mov_b32 s54, 1035273459
    v_mul_f32 v24, s54, v24
    v_mul_f32 v25, s54, v25
    v_mul_f32 v26, s54, v26
    v_mul_f32 v27, s54, v27
    v_cvt_pk_bf16_f32 v28, v24, v25
    v_lshlrev_b32 v24, 16, v28
    v_and_b32 v25, s72, v28
    v_cvt_pk_bf16_f32 v29, v26, v27
    v_lshlrev_b32 v26, 16, v29
    v_and_b32 v27, s72, v29
    v_max3_f32 v28, v24, v25, v26
    v_max_f32 v28, v28, v27
    s_nop 1
    v_max_f32_dpp v28, v28, v28 quad_perm:[1,0,3,2] row_mask:0xf bank_mask:0xf
    s_nop 1
    v_max_f32_dpp v28, v28, v28 quad_perm:[2,3,0,1] row_mask:0xf bank_mask:0xf
    v_mov_b32 v29, v28
    s_nop 1
    v_permlane16_swap_b32 v28, v29
    v_max_f32 v28, v28, v29
    v_mov_b32 v29, v28
    s_nop 1
    v_permlane32_swap_b32 v28, v29
    v_max_f32 v28, v28, v29
    v_min_u32 v28, -2, v28
    ds_write_b32 v164, v28 offset:1280
    s_cmp_eq_u32 s99, 32
    s_cbranch_scc1 Lh_B32
    s_cmp_eq_u32 s99, 31
    s_cbranch_scc1 Lh_B31
    s_cmp_eq_u32 s99, 30
    s_cbranch_scc1 Lh_B30
    s_cmp_eq_u32 s99, 29
    s_cbranch_scc1 Lh_B29
    s_cmp_eq_u32 s99, 28
    s_cbranch_scc1 Lh_B28
    s_cmp_eq_u32 s99, 27
    s_cbranch_scc1 Lh_B27
    s_cmp_eq_u32 s99, 26
    s_cbranch_scc1 Lh_B26
    s_cmp_eq_u32 s99, 25
    s_cbranch_scc1 Lh_B25
    s_cmp_eq_u32 s99, 24
    s_cbranch_scc1 Lh_B24
Lh_B23:
    s_waitcnt vmcnt(5)
    buffer_load_dwordx4 v[124:127], v5, s[48:51], s55 offen offset:3072 nt
Lh_B24:
    s_waitcnt vmcnt(5)
    buffer_load_dwordx4 v[128:131], v5, s[48:51], s56 offen offset:0 nt
Lh_B25:
    s_waitcnt vmcnt(5)
    buffer_load_dwordx4 v[132:135], v5, s[48:51], s56 offen offset:1024 nt
Lh_B26:
    s_waitcnt vmcnt(5)
    buffer_load_dwordx4 v[136:139], v5, s[48:51], s56 offen offset:2048 nt
Lh_B27:
    s_waitcnt vmcnt(5)
    buffer_load_dwordx4 v[140:143], v5, s[48:51], s56 offen offset:3072 nt
Lh_B28:
    s_waitcnt vmcnt(5)
    buffer_load_dwordx4 v[144:147], v5, s[48:51], s57 offen offset:0 nt
Lh_B29:
    s_waitcnt vmcnt(5)
    buffer_load_dwordx4 v[148:151], v5, s[48:51], s57 offen offset:1024 nt
Lh_B30:
    s_waitcnt vmcnt(5)
    buffer_load_dwordx4 v[152:155], v5, s[48:51], s57 offen offset:2048 nt
Lh_B31:
    s_waitcnt vmcnt(5)
    buffer_load_dwordx4 v[156:159], v5, s[48:51], s57 offen offset:3072 nt
    s_mov_b64 exec, 1
    ds_add_u32 v163, v161 offset:12
    s_mov_b64 exec, -1
Lh_B32:
    s_waitcnt vmcnt(8)
    s_nop 0
    v_perm_b32 v32, v100, v96, s52
    v_perm_b32 v36, v100, v96, s53
    v_perm_b32 v40, v101, v97, s52
    v_perm_b32 v44, v101, v97, s53
    v_perm_b32 v48, v102, v98, s52
    v_perm_b32 v52, v102, v98, s53
    v_perm_b32 v56, v103, v99, s52
    v_perm_b32 v60, v103, v99, s53
    v_perm_b32 v33, v108, v104, s52
    v_perm_b32 v37, v108, v104, s53
    v_perm_b32 v41, v109, v105, s52
    v_perm_b32 v45, v109, v105, s53
    v_perm_b32 v49, v110, v106, s52
    v_perm_b32 v53, v110, v106, s53
    v_perm_b32 v57, v111, v107, s52
    v_perm_b32 v61, v111, v107, s53
    v_perm_b32 v34, v116, v112, s52
    v_perm_b32 v38, v116, v112, s53
    v_perm_b32 v42, v117, v113, s52
    v_perm_b32 v46, v117, v113, s53
    v_perm_b32 v50, v118, v114, s52
    v_perm_b32 v54, v118, v114, s53
    v_perm_b32 v58, v119, v115, s52
    v_perm_b32 v62, v119, v115, s53
    v_perm_b32 v35, v124, v120, s52
    v_perm_b32 v39, v124, v120, s53
    v_perm_b32 v43, v125, v121, s52
    v_perm_b32 v47, v125, v121, s53
    v_perm_b32 v51, v126, v122, s52
    v_perm_b32 v55, v126, v122, s53
    v_perm_b32 v59, v127, v123, s52
    v_perm_b32 v63, v127, v123, s53
    s_mov_b32 s39, 320000
Lb3_79:
    ds_read_b128 v[8:11], v7 offset:1280
    ds_read_b128 v[12:15], v7 offset:1296
    s_sub_u32 s39, s39, 1
    s_cbranch_scc1 Lb3x_80
    s_waitcnt lgkmcnt(0)
    v_max3_u32 v16, v8, v9, v10
    v_max3_u32 v17, v11, v12, v13
    v_max3_u32 v16, v16, v14, v15
    v_max_u32 v16, v16, v17
    v_cmp_eq_u32 vcc, -1, v16
    s_cbranch_vccnz Lb3_79
Lb3x_80:
    s_mov_b32 s54, 1069066811
    s_waitcnt lgkmcnt(0)
    v_max3_f32 v8, v8, v9, v10
    v_max3_f32 v12, v11, v12, v13
    v_max3_f32 v8, v8, v14, v15
    v_max_f32 v8, v8, v12
    v_mul_f32 v162, s54, v8
    v_fma_f32 v24, v24, s54, -v162
    v_fma_f32 v25, v25, s54, -v162
    v_fma_f32 v26, v26, s54, -v162
    v_fma_f32 v27, v27, s54, -v162
    v_exp_f32 v24, v24
    v_exp_f32 v25, v25
    v_exp_f32 v26, v26
    v_exp_f32 v27, v27
    v_mov_b32_dpp v28, v24 quad_perm:[1,1,3,3] row_mask:0xf bank_mask:0xf
    v_mov_b32_dpp v29, v25 quad_perm:[1,1,3,3] row_mask:0xf bank_mask:0xf
    v_mov_b32_dpp v30, v26 quad_perm:[1,1,3,3] row_mask:0xf bank_mask:0xf
    v_mov_b32_dpp v31, v27 quad_perm:[1,1,3,3] row_mask:0xf bank_mask:0xf
    v_cvt_pk_bf16_f32 v8, v24, v28
    v_cvt_pk_bf16_f32 v10, v25, v29
    v_cvt_pk_bf16_f32 v12, v26, v30
    v_cvt_pk_bf16_f32 v14, v27, v31
    v_mov_b32_dpp v9, v8 quad_perm:[2,2,2,2] row_mask:0xf bank_mask:0xf
    v_mov_b32_dpp v11, v10 quad_perm:[2,2,2,2] row_mask:0xf bank_mask:0xf
    v_mov_b32_dpp v13, v12 quad_perm:[2,2,2,2] row_mask:0xf bank_mask:0xf
    v_mov_b32_dpp v15, v14 quad_perm:[2,2,2,2] row_mask:0xf bank_mask:0xf
    v_mfma_f32_16x16x32_bf16 v[96:99], v[8:11], v[32:35], 0
    v_mfma_f32_16x16x32_bf16 v[100:103], v[8:11], v[36:39], 0
    v_mfma_f32_16x16x32_bf16 v[104:107], v[8:11], v[40:43], 0
    v_mfma_f32_16x16x32_bf16 v[108:111], v[8:11], v[44:47], 0
    v_mfma_f32_16x16x32_bf16 v[112:115], v[8:11], v[48:51], 0
    v_mfma_f32_16x16x32_bf16 v[116:119], v[8:11], v[52:55], 0
    v_mfma_f32_16x16x32_bf16 v[120:123], v[8:11], v[56:59], 0
    v_mfma_f32_16x16x32_bf16 v[124:127], v[8:11], v[60:63], 0
    v_add_f32 v24, v24, v25
    v_add_f32 v26, v26, v27
    v_add_f32 v24, v24, v26
    s_nop 1
    v_add_f32_dpp v24, v24, v24 quad_perm:[1,0,3,2] row_mask:0xf bank_mask:0xf
    s_nop 1
    v_add_f32_dpp v24, v24, v24 quad_perm:[2,3,0,1] row_mask:0xf bank_mask:0xf
    v_mov_b32 v25, v24
    s_nop 1
    v_permlane16_swap_b32 v24, v25
    v_add_f32 v24, v24, v25
    v_mov_b32 v25, v24
    s_nop 1
    v_permlane32_swap_b32 v24, v25
    v_add_f32 v24, v24, v25
    v_min_u32 v24, -2, v24
    v_mov_b32 v31, 0xff
    v_mov_b32 v28, v162
    v_mov_b32 v30, s37
    s_cmp_eq_u32 s3, 7
    s_cselect_b32 s54, 0xffff, 0
    s_and_b32 s68, s64, s54
    s_mov_b32 s69, 0
    s_and_b32 s70, s66, s54
    s_mov_b32 s71, 0
    s_waitcnt vmcnt(4)
    v_perm_b32 v64, v132, v128, s52
    v_perm_b32 v68, v132, v128, s53
    v_perm_b32 v72, v133, v129, s52
    v_perm_b32 v76, v133, v129, s53
    v_perm_b32 v80, v134, v130, s52
    v_perm_b32 v84, v134, v130, s53
    v_perm_b32 v88, v135, v131, s52
    v_perm_b32 v92, v135, v131, s53
    v_perm_b32 v65, v140, v136, s52
    v_perm_b32 v69, v140, v136, s53
    v_perm_b32 v73, v141, v137, s52
    v_perm_b32 v77, v141, v137, s53
    v_perm_b32 v81, v142, v138, s52
    v_perm_b32 v85, v142, v138, s53
    v_perm_b32 v89, v143, v139, s52
    v_perm_b32 v93, v143, v139, s53
    s_waitcnt vmcnt(2)
    v_perm_b32 v66, v148, v144, s52
    v_perm_b32 v70, v148, v144, s53
    v_perm_b32 v74, v149, v145, s52
    v_perm_b32 v78, v149, v145, s53
    v_perm_b32 v82, v150, v146, s52
    v_perm_b32 v86, v150, v146, s53
    v_perm_b32 v90, v151, v147, s52
    v_perm_b32 v94, v151, v147, s53
    s_waitcnt vmcnt(0)
    v_perm_b32 v67, v156, v152, s52
    v_perm_b32 v71, v156, v152, s53
    v_perm_b32 v75, v157, v153, s52
    v_perm_b32 v79, v157, v153, s53
    v_perm_b32 v83, v158, v154, s52
    v_perm_b32 v87, v158, v154, s53
    v_perm_b32 v91, v159, v155, s52
    v_perm_b32 v95, v159, v155, s53
    v_mfma_f32_16x16x32_bf16 v[96:99], v[12:15], v[64:67], v[96:99]
    v_mfma_f32_16x16x32_bf16 v[100:103], v[12:15], v[68:71], v[100:103]
    v_mfma_f32_16x16x32_bf16 v[104:107], v[12:15], v[72:75], v[104:107]
    v_mfma_f32_16x16x32_bf16 v[108:111], v[12:15], v[76:79], v[108:111]
    v_mfma_f32_16x16x32_bf16 v[112:115], v[12:15], v[80:83], v[112:115]
    v_mfma_f32_16x16x32_bf16 v[116:119], v[12:15], v[84:87], v[116:119]
    v_mfma_f32_16x16x32_bf16 v[120:123], v[12:15], v[88:91], v[120:123]
    v_mfma_f32_16x16x32_bf16 v[124:127], v[12:15], v[92:95], v[124:127]
    s_nop 0
    ds_write_b32 v165, v96 offset:0
    ds_write_b32 v165, v100 offset:256
    ds_write_b32 v165, v104 offset:512
    ds_write_b32 v165, v108 offset:768
    ds_write_b32 v165, v112 offset:1024
    ds_write_b32 v165, v116 offset:1280
    ds_write_b32 v165, v120 offset:1536
    ds_write_b32 v165, v124 offset:1792
    ds_write_b32 v164, v24 offset:1408
    s_mov_b32 s39, 320000
Lb4_81:
    ds_read_b128 v[16:19], v7 offset:1408
    ds_read_b128 v[20:23], v7 offset:1424
    ds_read_b128 v[8:11], v166
    ds_read_b128 v[12:15], v166 offset:2080
    s_sub_u32 s39, s39, 1
    s_cbranch_scc1 Lb4x_82
    s_waitcnt lgkmcnt(2)
    v_max3_u32 v24, v16, v17, v18
    v_max3_u32 v25, v19, v20, v21
    v_max3_u32 v24, v24, v22, v23
    v_max_u32 v24, v24, v25
    v_cmp_eq_u32 vcc, -1, v24
    s_waitcnt lgkmcnt(0)
    s_cbranch_vccnz Lb4_81
Lb4x_82:
    s_waitcnt lgkmcnt(0)
    v_add_f32 v8, v8, v12
    v_add_f32 v9, v9, v13
    v_add_f32 v10, v10, v14
    v_add_f32 v11, v11, v15
    v_add_f32_dpp v8, v8, v8 quad_perm:[1,0,3,2] row_mask:0xf bank_mask:0xf
    v_add_f32_dpp v9, v9, v9 quad_perm:[1,0,3,2] row_mask:0xf bank_mask:0xf
    v_add_f32_dpp v10, v10, v10 quad_perm:[1,0,3,2] row_mask:0xf bank_mask:0xf
    v_add_f32_dpp v11, v11, v11 quad_perm:[1,0,3,2] row_mask:0xf bank_mask:0xf
    v_add_f32_dpp v8, v8, v8 quad_perm:[2,3,0,1] row_mask:0xf bank_mask:0xf
    v_add_f32_dpp v9, v9, v9 quad_perm:[2,3,0,1] row_mask:0xf bank_mask:0xf
    v_add_f32_dpp v10, v10, v10 quad_perm:[2,3,0,1] row_mask:0xf bank_mask:0xf
    v_add_f32_dpp v11, v11, v11 quad_perm:[2,3,0,1] row_mask:0xf bank_mask:0xf
    v_bfi_b32 v8, v31, s6, v8
    v_bfi_b32 v9, v31, s7, v9
    v_bfi_b32 v10, v31, s8, v10
    v_bfi_b32 v11, v31, s9, v11
    s_mov_b64 exec, s[64:65]
    buffer_store_dwordx4 v[8:11], v167, s[40:43], 0 offen
    s_mov_b64 exec, s[66:67]
    buffer_store_dwordx4 v[8:11], v167, s[40:43], 0 offen sc1
    s_mov_b64 exec, -1
    s_cmp_lg_u32 s3, 7
    s_cbranch_scc1 Lh_nost
    v_pk_add_f32 v[16:17], v[16:17], v[18:19]
    v_pk_add_f32 v[20:21], v[20:21], v[22:23]
    v_pk_add_f32 v[16:17], v[16:17], v[20:21]
    v_add_f32 v29, v16, v17
    s_mov_b64 exec, s[68:69]
    buffer_store_dwordx3 v[28:30], v160, s[40:43], 0 offen
    s_mov_b64 exec, s[70:71]
    buffer_store_dwordx3 v[28:30], v160, s[40:43], 0 offen sc1
    s_mov_b64 exec, -1
Lh_nost:
    s_mov_b64 exec, 1
    ds_add_u32 v163, v161 offset:16
    s_mov_b64 exec, -1
    s_mov_b64 exec, 1
    ds_add_u32 v163, v161 offset:28
    s_mov_b64 exec, -1
Lh_send:
    s_endpgm
Lh_qk21:
    buffer_load_dwordx4 v[120:123], v5, s[48:51], s55 offen offset:2048 nt
    s_mov_b64 exec, 1
    ds_add_u32 v163, v161 offset:20
    s_mov_b64 exec, -1
    s_mov_b32 s99, 23
    s_branch Lh_QK
Lh_qk22:
    buffer_load_dwordx4 v[124:127], v5, s[48:51], s55 offen offset:3072 nt
    s_mov_b32 s99, 24
    s_branch Lh_QK
Lh_qk23:
    buffer_load_dwordx4 v[128:131], v5, s[48:51], s56 offen offset:0 nt
    s_mov_b32 s99, 25
    s_branch Lh_QK
Lh_qk24:
    buffer_load_dwordx4 v[132:135], v5, s[48:51], s56 offen offset:1024 nt
    s_mov_b32 s99, 26
    s_branch Lh_QK
Lh_qk25:
    buffer_load_dwordx4 v[136:139], v5, s[48:51], s56 offen offset:2048 nt
    s_mov_b32 s99, 27
    s_branch Lh_QK
Lh_qk26:
    buffer_load_dwordx4 v[140:143], v5, s[48:51], s56 offen offset:3072 nt
    s_mov_b32 s99, 28
    s_branch Lh_QK
Lh_qk27:
    buffer_load_dwordx4 v[144:147], v5, s[48:51], s57 offen offset:0 nt
    s_mov_b32 s99, 29
    s_branch Lh_QK
Lh_qk28:
    buffer_load_dwordx4 v[148:151], v5, s[48:51], s57 offen offset:1024 nt
    s_mov_b32 s99, 30
    s_branch Lh_QK
Lh_qk29:
    buffer_load_dwordx4 v[152:155], v5, s[48:51], s57 offen offset:2048 nt
    s_mov_b32 s99, 31
    s_branch Lh_QK
Lh_qk30:
    buffer_load_dwordx4 v[156:159], v5, s[48:51], s57 offen offset:3072 nt
    s_mov_b64 exec, 1
    ds_add_u32 v163, v161 offset:12
    s_mov_b64 exec, -1
    s_mov_b32 s99, 32
    s_branch Lh_QK
.p2align 8
L_last:
.section .rodata,"a"
.p2align 6
.amdhsa_kernel adaLN_cond__sliding_block_cached__geglu_ffn__decode_kernel
  .amdhsa_next_free_vgpr 168
  .amdhsa_next_free_sgpr 102
  .amdhsa_accum_offset 168
  .amdhsa_group_segment_fixed_size 0
  .amdhsa_kernarg_size 112
  .amdhsa_user_sgpr_count 2
  .amdhsa_user_sgpr_kernarg_segment_ptr 1
  .amdhsa_system_sgpr_workgroup_id_x 1
.end_amdhsa_kernel
```
